```python
import torch

def _softmax(x, axis=-1):
    return torch.softmax(x, dim=axis)
def _gelu(x):
    return torch.nn.functional.gelu(x, approximate="tanh")
def _silu(x):
    return torch.nn.functional.silu(x)
def _sigmoid(x):
    return torch.sigmoid(x)
def _layernorm(x, axis=-1, eps=1e-5):
    m = x.mean(dim=axis, keepdim=True)
    v = x.var(dim=axis, keepdim=True, unbiased=False)
    return (x - m) / torch.sqrt(v + eps)
def _scatter_add(tgt, idx, src, axis=0):
    return tgt.clone().index_add_(axis, idx, src)
def _segment_sum(src, seg, n):
    out = torch.zeros((n,) + src.shape[1:], dtype=src.dtype)
    return out.index_add_(0, seg, src)
def _pad(x, pw):
    flat = tuple(v for pair in reversed(pw) for v in pair)
    return torch.nn.functional.pad(x, flat)

kernel_name = 'gated_mix__grouped_kv_mqa__dense_activation_relu__prompt'

def setup_inputs():

    _w = (lambda a: (lambda t: t.to(torch.bfloat16) if t.is_floating_point() else t)(torch.as_tensor(a)))
    def _A_setup():
        B, S, D, H = 1, 2048, 640, 32
        Dh = D // H
        return {
            "x": _w((lambda *s: torch.randn(*s, dtype=torch.bfloat16) * 0.05)(B, S, D)),
            "wq": _w((lambda *s: torch.randn(*s, dtype=torch.bfloat16) * 0.8)(D, H * Dh)),
            "wk": _w((lambda *s: torch.randn(*s, dtype=torch.bfloat16) * 0.8)(D, Dh)),
            "wv": _w((lambda *s: torch.randn(*s, dtype=torch.bfloat16) * 0.2)(D, Dh)),
            "wo": _w((lambda *s: torch.randn(*s, dtype=torch.bfloat16) * 0.2)(H * Dh, D)),
        }
    _A_in = _A_setup()

    def _B_setup():
        B, S, D, Dff = 1, 2048, 640, 1536
        return {
            "x": _w((lambda *s: torch.randn(*s, dtype=torch.bfloat16) * 0.05)(B, S, D)),
            "w1": _w((lambda *s: torch.randn(*s, dtype=torch.bfloat16) * 0.05)(D, Dff)),
            "w2": _w((lambda *s: torch.randn(*s, dtype=torch.bfloat16) * 0.05)(Dff, D)),
        }
    _B_in = _B_setup()

    return {
        "A_x": _A_in["x"],
        "A_wq": _A_in["wq"],
        "A_wk": _A_in["wk"],
        "A_wv": _A_in["wv"],
        "A_wo": _A_in["wo"],
        "B_x": _B_in["x"],
        "B_w1": _B_in["w1"],
        "B_w2": _B_in["w2"],
        "gate_w": _w((lambda *s: torch.randn(*s, dtype=torch.bfloat16) * 0.05)(640) * 16.0),
    }

def reference(A_x, A_wq, A_wk, A_wv, A_wo, B_x, B_w1, B_w2, gate_w):
    def _A_ref(x, wq, wk, wv, wo):
        B, S, D = x.shape
        H = 32
        Dh = D // H
        q = (lambda x, *d: x.permute(*d))((x @ wq).reshape(B, S, H, Dh), 0, 2, 1, 3)
        k = x @ wk
        v = x @ wv
        scores = torch.einsum("bhqd,bkd->bhqk", q, k) * (Dh ** -0.5)
        p = _softmax(scores, axis=-1)
        o = torch.einsum("bhqk,bkd->bhqd", p, v)
        return (lambda x, *d: x.permute(*d))(o, 0, 2, 1, 3).reshape(B, S, H * Dh) @ wo

    def _B_ref(x, w1, w2):
        h = torch.einsum("bsd,df->bsf", x, w1)
        zero = torch.zeros_like(h)
        h = torch.maximum(h, zero)
        return torch.einsum("bsf,fd->bsd", h, w2)

    x = A_x
    g = _sigmoid((x * gate_w).sum(-1, keepdims=True))
    a = _A_ref(x, A_wq, A_wk, A_wv, A_wo)
    b = _B_ref(x, B_w1, B_w2)
    return g * a + (1 - g) * b
```

```asm
; @launch grid=(256,1,1) block=(256,1,1) lds=163840
.amdgcn_target "amdgcn-amd-amdhsa--gfx950"
.text
.globl gated_mix__grouped_kv_mqa__dense_activation_relu__prompt_kernel
.p2align 8
.type gated_mix__grouped_kv_mqa__dense_activation_relu__prompt_kernel,@function
gated_mix__grouped_kv_mqa__dense_activation_relu__prompt_kernel:
    s_cmp_ge_u32 s2, 256
    s_cbranch_scc1 L_end
    s_load_dwordx16 s[48:63], s[0:1], 0
    s_load_dwordx8 s[64:71], s[0:1], 64
    v_lshrrev_b32 v29, 6, v0
    v_and_b32_e64 v28, 63, v0
    v_readfirstlane_b32 s44, v29
    s_and_b32 s72, s2, 7
    s_lshr_b32 s83, s2, 3
    s_lshr_b32 s45, s72, 1
    s_lshl_b32 s45, s45, 3
    s_lshr_b32 s47, s83, 2
    s_add_u32 s45, s45, s47
    s_and_b32 s46, s72, 1
    s_lshl_b32 s46, s46, 2
    s_and_b32 s73, s83, 3
    s_add_u32 s46, s46, s73
    s_add_u32 s47, s47, s73
    s_mul_i32 s72, s47, 52
    s_lshr_b32 s72, s72, 8
    s_mul_i32 s72, s72, 5
    s_sub_u32 s47, s47, s72
    s_mov_b32 s6, 2621440
    s_mov_b32 s7, 0x20000
    s_mov_b32 s10, 819200
    s_mov_b32 s11, 0x20000
    s_mov_b32 s18, 819200
    s_mov_b32 s19, 0x20000
    s_mov_b32 s22, 1966080
    s_mov_b32 s23, 0x20000
    s_mov_b32 s26, 1966080
    s_mov_b32 s27, 0x20000
    s_mov_b32 s30, 1280
    s_mov_b32 s31, 0x20000
    s_mov_b32 s34, 2621440
    s_mov_b32 s35, 0x20000
    s_mov_b32 s38, 256
    s_mov_b32 s39, 0x20000
    s_mov_b32 s42, 16777216
    s_mov_b32 s43, 0x20000
    s_lshr_b32 s72, s46, 1
    s_xor_b32 s72, s72, s46
    s_and_b32 s72, s72, 2
    s_mul_i32 s72, s72, 3
    s_xor_b32 s82, s46, s72
    s_cmp_lt_u32 s82, 4
    s_cselect_b32 s14, 25600, 0
    s_mov_b32 s15, 0x20000
    v_lshlrev_b32 v1, 4, v28
    v_lshrrev_b32 v29, 3, v28
    v_lshrrev_b32 v247, 4, v28
    v_and_b32_e64 v30, 7, v28
    v_xor_b32 v30, v30, v247
    v_mul_u32_u24 v29, 1280, v29
    v_lshl_add_u32 v234, v30, 4, v29
    v_xor_b32 v235, 64, v234
    v_add_u32 v235, 9216, v235
    s_lshl_b32 s72, s47, 7
    v_add_u32 v29, s72, v0
    v_add_u32 v29, 0, v29
    v_subrev_u32 v30, 640, v29
    v_min_u32 v29, v29, v30
    v_lshlrev_b32 v244, 1, v29
    v_add_u32_e64 v29, s72, v0
    v_add_u32 v29, 256, v29
    v_subrev_u32 v30, 640, v29
    v_min_u32 v29, v29, v30
    v_lshlrev_b32 v245, 1, v29
    v_add_u32_e64 v29, s72, v0
    v_add_u32 v29, 512, v29
    v_subrev_u32 v30, 640, v29
    v_min_u32 v29, v29, v30
    v_lshlrev_b32_e64 v246, 1, v29
    s_waitcnt lgkmcnt(0)
    s_mov_b64 s[4:5], s[48:49]
    s_mov_b64 s[8:9], s[50:51]
    s_mov_b64 s[16:17], s[56:57]
    s_mov_b64 s[20:21], s[60:61]
    s_mov_b64 s[24:25], s[62:63]
    s_mov_b64 s[28:29], s[64:65]
    s_mov_b64 s[32:33], s[66:67]
    s_mov_b64 s[36:37], s[68:69]
    s_mov_b64 s[40:41], s[70:71]
    s_bitcmp1_b32 s82, 1
    s_cselect_b64 s[12:13], s[54:55], s[52:53]
    s_mov_b32 s48, s47
    s_lshl_b32 s60, s45, 2
    s_add_u32 s60, s60, s44
    s_mul_i32 s60, s60, 20480
    s_lshl_b32 s79, s44, 11
    s_add_u32 s49, s48, 1
    s_cmp_ge_u32 s49, 5
    s_cselect_b32 s49, 0, s49
    s_add_u32 s50, s49, 1
    s_cmp_ge_u32 s50, 5
    s_cselect_b32 s50, 0, s50
    s_add_u32 s51, s50, 1
    s_cmp_ge_u32 s51, 5
    s_cselect_b32 s51, 0, s51
    s_add_u32 s52, s51, 1
    s_cmp_ge_u32 s52, 5
    s_cselect_b32 s52, 0, s52
    s_cmp_ge_u32 s82, 4
    s_cbranch_scc1 L_nokvw
    s_lshl_b32 s55, s44, 10
    s_add_u32 m0, s55, 134144
    s_mul_i32 s54, s48, 5120
    s_add_u32 s54, s54, s55
    buffer_load_dwordx4 v1, s[12:15], s54 offen lds
    s_add_u32 m0, s55, 139264
    s_mul_i32 s54, s49, 5120
    s_add_u32 s54, s54, s55
    buffer_load_dwordx4 v1, s[12:15], s54 offen lds
    s_add_u32 m0, s55, 144384
    s_mul_i32 s54, s50, 5120
    s_add_u32 s54, s54, s55
    buffer_load_dwordx4 v1, s[12:15], s54 offen lds
    s_add_u32 m0, s55, 149504
    s_mul_i32 s54, s51, 5120
    s_add_u32 s54, s54, s55
    buffer_load_dwordx4 v1, s[12:15], s54 offen lds
    s_add_u32 m0, s55, 154624
    s_mul_i32 s54, s52, 5120
    s_add_u32 s54, s54, s55
    buffer_load_dwordx4 v1, s[12:15], s54 offen lds
    s_add_u32 s54, s47, s44
    s_cmp_ge_u32 s54, 5
    s_cselect_b32 s55, 5, 0
    s_sub_u32 s54, s54, s55
    s_mul_i32 s55, s44, 5120
    s_add_u32 m0, s55, 138240
    s_mul_i32 s54, s54, 5120
    s_add_u32 s54, s54, 4096
    buffer_load_dwordx4 v1, s[12:15], s54 offen lds
    s_mov_b32 m0, 158720
    s_mul_i32 s54, s52, 5120
    s_add_u32 s54, s54, 4096
    buffer_load_dwordx4 v1, s[12:15], s54 offen lds
L_nokvw:
    buffer_load_ushort v244, v244, s[28:31], 0 offen
    buffer_load_ushort v245, v245, s[28:31], 0 offen
    buffer_load_ushort v246, v246, s[28:31], 0 offen
    s_lshl_b32 s54, s48, 8
    s_add_u32 m0, s79, 0
    s_add_u32 s54, s54, s60
    buffer_load_dwordx4 v234, s[4:7], s54 offen lds
    buffer_load_dwordx4 v235, s[4:7], s54 offen offset:1024 lds
    s_lshl_b32 s58, s46, 2
    s_add_u32 s56, s58, s44
    s_lshl_b32 s56, s56, 2
    s_lshl_b32 s59, s45, 7
    s_add_u32 s76, s59, 262144
    s_add_u32 s77, s59, 270336
    s_add_u32 s56, s56, s76
    s_add_u32 s58, s58, s77
    v_mov_b32_e64 v29, 0
    v_mov_b32 v30, 2147483648
    v_cmp_eq_u32 vcc, 0, v28
    s_nop 1
    v_cndmask_b32 v17, v30, v29, vcc
    v_cmp_eq_u32 vcc, 0, v0
    s_nop 1
    v_cndmask_b32 v253, v30, v29, vcc
    v_or_b32 v13, s56, v17
    v_mov_b32 v14, 1
    buffer_store_dword v29, v13, s[40:43], 0 offen sc1
    buffer_store_dword v29, v253, s[40:43], s58 offen sc1
    s_lshl_b32 s70, s45, 1
    s_add_u32 s70, s70, s44
    s_add_u32 s56, s45, 64
    s_min_u32 s56, s56, 68
    s_cmp_eq_u32 s44, 2
    s_cselect_b32 s70, s56, s70
    s_cmp_eq_u32 s44, 3
    s_cselect_b32 s70, 68, s70
    s_lshl_b32 s56, s46, 7
    s_add_u32 s56, s56, s70
    s_lshl_b32 s56, s56, 2
    s_add_u32 s56, s56, 278528
    s_cmp_ge_u32 s70, 68
    s_cselect_b32 s56, 2147483648, s56
    v_or_b32 v11, s56, v17
    buffer_store_dword v29, v11, s[40:43], 0 offen sc1
    s_getpc_b64 s[66:67]
L_pc:
    s_lshl_b32 s58, s83, 11
    v_lshlrev_b32 v30, 7, v28
    v_add_u32 v30, s58, v30
    v_cmp_gt_u32 vcc, L_end-L_pc, v30
    s_nop 0
    s_and_b64 vcc, vcc, 0xffff
    s_cmp_eq_u32 s44, 0
    s_cselect_b64 vcc, vcc, 0
    s_and_saveexec_b64 s[64:65], vcc
    s_cbranch_execz L_nowarm
    global_load_dword v255, v30, s[66:67]
L_nowarm:
    s_mov_b64 exec, -1
    s_add_u32 m0, s79, 8192
    s_add_u32 s54, s54, 128
    buffer_load_dwordx4 v234, s[4:7], s54 offen lds
    v_bfe_u32 v248, v28, 2, 2
    v_and_b32 v249, 3, v28
    v_and_b32 v250, 15, v28
    v_mov_b32 v2, 0xdddd
    s_mov_b32 s80, 0
    s_mov_b32 s81, -1
    v_lshrrev_b32 v29, 1, v247
    v_lshlrev_b32 v29, 4, v29
    v_and_b32_e64 v30, 1, v247
    v_lshl_add_u32 v29, v30, 2, v29
    v_add_u32 v251, v29, v248
    v_lshlrev_b32 v31, 3, v249
    v_mul_u32_u24 v29, 160, v251
    v_add_u32_e64 v29, v29, v31
    v_add_u32 v15, 94208, v29
    s_and_b32 s59, s46, 1
    s_lshl_b32 s59, s59, 4
    s_add_u32 s59, s59, 134144
    v_lshl_add_u32 v29, v247, 3, v248
    v_mul_u32_u24 v29, 40, v29
    buffer_load_dwordx4 v235, s[4:7], s54 offen offset:1024 lds
    v_mov_b32 v36, 0
    v_mov_b32_e64 v37, 0
    v_add3_u32 v236, v29, v31, s59
    v_mul_u32_u24 v29, 40, v0
    s_add_u32 s59, s59, 24
    v_add_u32 v237, s59, v29
    v_mov_b32 v0, v253
    v_lshrrev_b32 v29, 1, v250
    v_xor_b32 v29, v29, v247
    v_lshlrev_b32_e64 v29, 4, v29
    v_mfma_f32_32x32x8_bf16 a[192:207], v[36:37], v[36:37], 0
    v_lshl_add_u32 v29, v250, 7, v29
    v_add_u32 v216, s79, v29
    v_xor_b32 v218, 64, v216
    v_add_u32 v217, 40960, v216
    v_add_u32 v219, 40960, v218
    v_and_b32_e64 v30, 31, v28
    v_bfe_u32 v29, v28, 1, 3
    v_lshrrev_b32 v31, 5, v28
    v_xor_b32 v29, v29, v31
    s_lshl_b32 s54, s49, 8
    s_add_u32 m0, s79, 16384
    s_add_u32 s54, s54, s60
    buffer_load_dwordx4 v234, s[4:7], s54 offen lds
    v_mfma_f32_32x32x8_bf16 a[208:223], v[36:37], v[36:37], 0
    v_lshlrev_b32_e64 v29, 4, v29
    v_lshl_add_u32 v29, v30, 7, v29
    s_and_b32 s59, s44, 1
    s_lshl_b32 s59, s59, 12
    v_add_u32_e64 v220, s59, v29
    v_xor_b32 v222, 32, v220
    v_xor_b32 v224, 64, v220
    v_xor_b32 v226, 96, v220
    v_add_u32 v221, 40960, v220
    v_mfma_f32_32x32x8_bf16 a[224:239], v[36:37], v[36:37], 0
    v_add_u32 v223, 40960, v222
    v_add_u32 v225, 40960, v224
    v_add_u32 v227, 40960, v226
    v_add_u32_e64 v29, 0, v28
    v_mul_u32_u24 v30, 2731, v29
    v_lshrrev_b32 v30, 16, v30
    v_mul_u32_u24 v31, 24, v30
    v_sub_u32 v31, v29, v31
    v_and_b32 v29, 2, v30
    buffer_load_dwordx4 v235, s[4:7], s54 offen offset:1024 lds
    v_mfma_f32_32x32x8_bf16 a[240:255], v[36:37], v[36:37], 0
    v_lshlrev_b32 v29, 1, v29
    v_xor_b32 v31, v31, v29
    v_mul_u32_u24 v30, 3072, v30
    v_lshl_add_u32 v231, v31, 4, v30
    v_add_u32_e64 v29, 64, v28
    v_mul_u32_u24 v30, 2731, v29
    v_lshrrev_b32 v30, 16, v30
    v_mul_u32_u24 v31, 24, v30
    v_sub_u32 v31, v29, v31
    v_and_b32 v29, 2, v30
    v_lshlrev_b32 v29, 1, v29
    v_xor_b32 v31, v31, v29
    v_mul_u32_u24 v30, 3072, v30
    v_lshl_add_u32 v232, v31, 4, v30
    v_subrev_u32 v232, 1024, v232
    v_add_u32 v29, 128, v28
    v_mul_u32_u24 v30, 2731, v29
    v_lshrrev_b32 v30, 16, v30
    v_mul_u32_u24 v31, 24, v30
    s_add_u32 m0, s79, 24576
    s_add_u32 s54, s54, 128
    buffer_load_dwordx4 v234, s[4:7], s54 offen lds
    v_sub_u32 v31, v29, v31
    v_and_b32 v29, 2, v30
    v_lshlrev_b32 v29, 1, v29
    v_xor_b32 v31, v31, v29
    v_mul_u32_u24 v30, 3072, v30
    v_lshl_add_u32 v233, v31, 4, v30
    v_subrev_u32 v233, 2048, v233
    s_mul_i32 s58, s44, 24576
    s_mul_i32 s62, s46, 384
    s_add_u32 s62, s62, s58
    v_lshrrev_b32 v29, 5, v28
    v_lshl_add_u32 v29, v29, 3, v248
    v_mul_u32_u24 v29, 384, v29
    v_lshl_add_u32 v29, v249, 3, v29
    v_and_b32_e64 v30, 1, v247
    v_lshl_add_u32 v29, v30, 5, v29
    v_add_u32 v29, 81920, v29
    v_lshrrev_b32 v30, 1, v248
    s_lshr_b32 s58, s44, 1
    s_mul_i32 s58, s58, 3
    buffer_load_dwordx4 v235, s[4:7], s54 offen offset:1024 lds
    s_add_u32 s59, s58, 0
    s_and_b32 s56, s59, 1
    s_lshr_b32 s59, s59, 1
    s_lshl_b32 s59, s59, 7
    v_xor_b32 v31, s56, v30
    v_lshl_add_u32 v31, v31, 6, v29
    v_add_u32 v228, s59, v31
    s_add_u32 s59, s58, 1
    s_and_b32 s56, s59, 1
    s_lshr_b32 s59, s59, 1
    s_lshl_b32 s59, s59, 7
    v_xor_b32 v31, s56, v30
    v_lshl_add_u32 v31, v31, 6, v29
    v_add_u32 v229, s59, v31
    s_add_u32 s59, s58, 2
    s_and_b32 s56, s59, 1
    s_lshr_b32 s59, s59, 1
    s_lshl_b32 s59, s59, 7
    v_xor_b32 v31, s56, v30
    v_lshl_add_u32 v31, v31, 6, v29
    s_lshl_b32 s54, s50, 8
    s_add_u32 m0, s79, 32768
    s_add_u32 s54, s54, s60
    buffer_load_dwordx4 v234, s[4:7], s54 offen lds
    v_add_u32 v230, s59, v31
    v_add_u32 v29, 0, v28
    v_mul_u32_u24 v30, 6554, v29
    v_lshrrev_b32 v30, 16, v30
    v_mul_u32_u24 v31, 10, v30
    v_sub_u32 v31, v29, v31
    v_and_b32 v29, 4, v30
    v_add_u32_e64 v30, v30, v29
    v_mul_u32_u24 v30, 1280, v30
    v_lshl_add_u32 v252, v31, 4, v30
    v_add_u32_e64 v29, 64, v28
    v_mul_u32_u24 v30, 6554, v29
    v_lshrrev_b32 v30, 16, v30
    v_mul_u32_u24 v31, 10, v30
    v_sub_u32 v31, v29, v31
    v_and_b32 v29, 4, v30
    v_add_u32_e64 v30, v30, v29
    v_mul_u32_u24 v30, 1280, v30
    v_lshl_add_u32 v254, v31, 4, v30
    v_subrev_u32 v254, 1024, v254
    buffer_load_dwordx4 v235, s[4:7], s54 offen offset:1024 lds
    s_lshr_b32 s58, s44, 1
    s_lshl_b32 s58, s58, 2
    s_and_b32 s59, s44, 1
    s_add_u32 s58, s58, s59
    s_mul_i32 s58, s58, 5120
    s_mul_i32 s61, s46, 160
    s_add_u32 s61, s61, s58
    s_mul_i32 s63, s44, 3072
    s_mul_i32 s69, s44, 1280
    v_and_b32 v30, 31, v28
    v_lshrrev_b32 v31, 5, v28
    s_and_b32 s58, s44, 1
    s_mul_i32 s58, s58, 5376
    s_add_u32 s58, s58, 151552
    v_mul_u32_u24 v239, 168, v30
    v_add_u32 v239, s58, v239
    v_lshlrev_b32_e64 v4, 3, v30
    v_min_u32 v30, 21, v30
    v_mul_u32_u24 v31, 384, v31
    v_lshl_add_u32 v3, v30, 4, v31
    s_add_u32 m0, s79, 40960
    s_add_u32 s54, s54, 128
    buffer_load_dwordx4 v234, s[4:7], s54 offen lds
    s_mul_i32 s58, s44, 2688
    s_add_u32 s58, s58, 151552
    v_mul_u32_u24 v238, 168, v250
    v_lshl_add_u32 v238, v247, 3, v238
    v_add_u32 v238, s58, v238
    v_mov_b32 v42, 0
    v_mov_b32 v43, 0
    v_mov_b32 v48, 0
    v_mov_b32 v49, 0
    v_mov_b32 v54, 0
    v_mov_b32 v55, 0
    s_xor_b32 s58, s44, 0
    s_lshl_b32 s58, s58, 10
    v_add_u32 v22, s58, v1
    s_xor_b32 s58, s44, 1
    s_lshl_b32 s58, s58, 10
    v_add_u32 v23, s58, v1
    s_xor_b32 s58, s44, 2
    s_lshl_b32 s58, s58, 10
    v_add_u32 v24, s58, v1
    buffer_load_dwordx4 v235, s[4:7], s54 offen offset:1024 lds
    s_xor_b32 s58, s44, 3
    s_lshl_b32 s58, s58, 10
    v_add_u32_e64 v25, s58, v1
    s_mul_i32 s74, s44, 30720
    v_mul_u32_u24 v30, 1280, v250
    v_lshl_add_u32 v18, v247, 3, v30
    v_and_b32 v30, 1, v247
    v_lshlrev_b32 v30, 10, v30
    v_lshl_add_u32 v30, v250, 4, v30
    v_lshrrev_b32 v29, 5, v28
    v_lshl_add_u32 v243, v29, 8, v30
    s_lshr_b32 s58, s44, 1
    s_mul_i32 s58, s58, 5
    s_mul_i32 s59, s46, 10
    s_add_u32 s58, s58, s59
    s_and_b32 s59, s44, 1
    s_lshl_b32 s59, s59, 11
    v_add_u32 v30, s59, v30
    v_mov_b32 v29, 0
    v_mov_b32_e64 v31, 2
    s_lshl_b32 s54, s51, 8
    s_add_u32 m0, s79, 49152
    s_add_u32 s54, s54, s60
    buffer_load_dwordx4 v234, s[4:7], s54 offen lds
    v_cndmask_b32 v29, v29, v31, s[80:81]
    v_add_u32 v29, s58, v29
    v_lshrrev_b32 v31, 2, v29
    v_lshlrev_b32 v31, 12, v31
    v_and_b32_e64 v29, 3, v29
    v_lshl_add_u32 v31, v29, 8, v31
    v_add_u32 v19, v31, v30
    v_mov_b32 v29, 1
    v_mov_b32_e64 v31, 1
    v_cndmask_b32 v29, v29, v31, s[80:81]
    v_add_u32 v29, s58, v29
    v_lshrrev_b32 v31, 2, v29
    v_lshlrev_b32 v31, 12, v31
    v_and_b32 v29, 3, v29
    v_lshl_add_u32 v31, v29, 8, v31
    v_add_u32 v20, v31, v30
    v_mov_b32 v29, 3
    v_mov_b32_e64 v31, 4
    v_cndmask_b32 v29, v29, v31, s[80:81]
    v_add_u32_e64 v29, s58, v29
    buffer_load_dwordx4 v235, s[4:7], s54 offen offset:1024 lds
    v_lshrrev_b32 v31, 2, v29
    v_lshlrev_b32 v31, 12, v31
    v_and_b32_e64 v29, 3, v29
    v_lshl_add_u32 v31, v29, 8, v31
    v_add_u32_e64 v21, v31, v30
    v_mov_b32 v31, 2147483648
    v_cndmask_b32 v20, v20, v31, s[80:81]
    s_mul_i32 s71, s45, 196608
    s_add_u32 s71, s71, 1048576
    s_mul_i32 s75, s45, 81920
    s_add_u32 s75, s75, 8388608
    s_cmp_ge_u32 s70, 48
    s_cselect_b32 s56, 4, 0
    v_add_u32_e64 v29, 0, v28
    v_mul_u32_u24 v30, 6554, v29
    v_lshrrev_b32 v30, 16, v30
    v_mul_u32_u24 v31, 10, v30
    v_sub_u32 v31, v29, v31
    v_lshrrev_b32 v29, 1, v30
    v_xor_b32 v29, v29, v30
    v_and_b32 v29, s56, v29
    s_add_u32 m0, s79, 57344
    s_add_u32 s54, s54, 128
    buffer_load_dwordx4 v234, s[4:7], s54 offen lds
    v_mul_u32_u24 v29, 3, v29
    v_xor_b32 v29, v29, v30
    v_mul_u32_u24 v29, 1280, v29
    v_lshl_add_u32 v5, v31, 4, v29
    v_add_u32_e64 v29, 64, v28
    v_mul_u32_u24 v30, 6554, v29
    v_lshrrev_b32 v30, 16, v30
    v_mul_u32_u24 v31, 10, v30
    v_sub_u32 v31, v29, v31
    v_lshrrev_b32 v29, 1, v30
    v_xor_b32 v29, v29, v30
    v_and_b32 v29, s56, v29
    v_mul_u32_u24 v29, 3, v29
    v_xor_b32 v29, v29, v30
    v_mul_u32_u24 v29, 1280, v29
    v_lshl_add_u32 v6, v31, 4, v29
    v_subrev_u32 v6, 1024, v6
    v_add_u32 v29, 128, v28
    v_mul_u32_u24 v30, 6554, v29
    v_lshrrev_b32 v30, 16, v30
    buffer_load_dwordx4 v235, s[4:7], s54 offen offset:1024 lds
    v_mul_u32_u24 v31, 10, v30
    v_sub_u32 v31, v29, v31
    v_lshrrev_b32 v29, 1, v30
    v_xor_b32 v29, v29, v30
    v_and_b32 v29, s56, v29
    v_mul_u32_u24 v29, 3, v29
    v_xor_b32 v29, v29, v30
    v_mul_u32_u24 v29, 1280, v29
    v_lshl_add_u32 v7, v31, 4, v29
    v_subrev_u32 v7, 2048, v7
    v_add_u32 v29, 192, v28
    v_mul_u32_u24 v30, 6554, v29
    v_lshrrev_b32 v30, 16, v30
    v_mul_u32_u24 v31, 10, v30
    v_sub_u32 v31, v29, v31
    v_lshrrev_b32 v29, 1, v30
    v_xor_b32 v29, v29, v30
    v_and_b32_e64 v29, s56, v29
    v_mul_u32_u24 v29, 3, v29
    v_xor_b32 v29, v29, v30
    s_lshl_b32 s54, s52, 8
    s_add_u32 m0, s79, 65536
    s_add_u32 s54, s54, s60
    buffer_load_dwordx4 v234, s[4:7], s54 offen lds
    v_mul_u32_u24 v29, 1280, v29
    v_lshl_add_u32 v8, v31, 4, v29
    v_subrev_u32 v8, 3072, v8
    v_add_u32 v29, 256, v28
    v_mul_u32_u24 v30, 6554, v29
    v_lshrrev_b32 v30, 16, v30
    v_mul_u32_u24 v31, 10, v30
    v_sub_u32 v31, v29, v31
    v_lshrrev_b32 v29, 1, v30
    v_xor_b32 v29, v29, v30
    v_and_b32_e64 v29, s56, v29
    v_mul_u32_u24 v29, 3, v29
    v_xor_b32 v29, v29, v30
    v_mul_u32_u24 v29, 1280, v29
    v_lshl_add_u32 v9, v31, 4, v29
    v_subrev_u32 v9, 3072, v9
    s_lshl_b32 s59, s44, 5
    s_add_u32 s59, s59, s76
    s_lshl_b32 s56, s46, 9
    s_add_u32 s56, s56, 278528
    s_mul_i32 s57, s44, 48
    s_add_u32 s57, s57, s56
    s_sub_u32 s57, s57, 32
    s_mul_i32 s58, s44, 20
    s_add_u32 s58, s58, s56
    s_add_u32 s58, s58, 112
    v_min_u32 v29, 24, v28
    v_cmp_gt_u32 vcc, 8, v29
    v_cmp_gt_u32 s[64:65], 20, v29
    v_mov_b32 v30, s58
    v_mov_b32 v31, s57
    v_mov_b32_e64 v12, s59
    v_cndmask_b32 v30, v30, v31, s[64:65]
    v_cndmask_b32 v30, v30, v12, vcc
    v_lshl_add_u32 v12, v29, 2, v30
    s_lshr_b32 s56, s44, 1
    s_lshl_b32 s56, s56, 17
    s_add_u32 s56, s56, 4096
    s_add_u32 s28, s40, s56
    s_addc_u32 s29, s41, 0
    s_mul_i32 s56, s44, 49152
    s_add_u32 s56, s56, s71
    s_add_u32 s56, s56, 4096
    s_add_u32 s30, s40, s56
    s_addc_u32 s31, s41, 0
    s_and_b32 s56, s44, 1
    s_and_b32 s57, s46, 1
    s_cmp_ge_u32 s82, 2
    s_cbranch_scc1 L_vrole
    s_lshl_b32 s58, s57, 1
    v_add_u32 v29, s58, v247
    s_lshl_b32 s59, s56, 4
    v_add_u32 v30, s59, v250
    v_lshrrev_b32 v31, 1, v29
    v_lshlrev_b32 v31, 9, v31
    v_lshl_add_u32 v31, v30, 4, v31
    v_and_b32 v240, 1, v29
    v_cmp_eq_u32 vcc, 4, v29
    v_lshl_add_u32 v31, v240, 3, v31
    v_lshlrev_b32_e64 v30, 3, v30
    v_add_u32 v30, 2560, v30
    v_cndmask_b32 v240, v31, v30, vcc
    v_cmp_eq_u32 vcc, 3, v247
    v_cmp_gt_u32 s[64:65], s57, v247
    v_mov_b32 v31, 2147483648
    s_or_b64 vcc, vcc, s[64:65]
    v_cndmask_b32 v240, v240, v31, vcc
    s_mov_b64 s[64:65], 0
    s_mov_b64 s[66:67], 0
    s_branch L_roledone
L_vrole:
    s_lshl_b32 s58, s57, 3
    v_add_u32 v29, s58, v250
    v_lshrrev_b32 v30, 2, v29
    v_cmp_le_u32 vcc, 12, v29
    v_lshlrev_b32 v30, 3, v30
    v_and_b32 v31, 3, v29
    v_add_u32 v30, v30, v31
    v_cndmask_b32 v30, v30, v29, vcc
    v_cmp_le_u32 vcc, 16, v29
    v_cmp_le_u32 s[66:67], 20, v29
    v_subrev_u32 v31, 12, v29
    v_cndmask_b32 v30, v30, v31, vcc
    v_cmp_eq_u32 vcc, 20, v29
    v_cndmask_b32 v30, v30, v29, s[66:67]
    v_mov_b32 v31, 0x3f803f80
    v_cndmask_b32 v242, 0, v31, vcc
    v_lshlrev_b32 v30, 4, v30
    v_lshrrev_b32 v31, 1, v247
    s_lshl_b32 s59, s56, 1
    v_add_u32 v31, s59, v31
    v_mul_u32_u24 v31, 384, v31
    v_add_u32 v30, v30, v31
    v_and_b32 v31, 1, v247
    v_lshl_add_u32 v30, v31, 3, v30
    s_lshl_b32 s59, s57, 2
    s_lshl_b32 s58, s57, 1
    s_add_u32 s58, s58, 12
    v_cmp_gt_u32 vcc, s59, v250
    v_cmp_le_u32 s[64:65], s58, v250
    v_add_u32 v240, 1024, v30
    v_mov_b32 v31, 2147483648
    s_or_b64 vcc, vcc, s[64:65]
    s_cmp_lt_u32 s82, 4
    s_cselect_b64 vcc, vcc, -1
    v_cndmask_b32 v240, v240, v31, vcc
    s_mov_b64 s[64:65], -1
L_roledone:
    s_mov_b32 s82, 0
    s_nop 0
    buffer_load_dwordx4 v235, s[4:7], s54 offen offset:1024 lds
    s_add_u32 m0, s79, 73728
    s_add_u32 s54, s54, 128
    buffer_load_dwordx4 v234, s[4:7], s54 offen lds
    buffer_load_dwordx4 v235, s[4:7], s54 offen offset:1024 lds
    s_add_u32 m0, s63, 81920
    s_mul_i32 s55, s48, 393216
    s_add_u32 s55, s55, s62
    buffer_load_dwordx4 v231, s[20:23], s55 offen lds
    buffer_load_dwordx4 v232, s[20:23], s55 offen offset:1024 lds
    buffer_load_dwordx4 v233, s[20:23], s55 offen offset:2048 lds
    s_add_u32 m0, s69, 94208
    s_mul_i32 s68, s48, 163840
    s_add_u32 s68, s68, s61
    buffer_load_dwordx4 v252, s[8:11], s68 offen lds
    s_mov_b64 exec, 0xffff
    buffer_load_dwordx4 v254, s[8:11], s68 offen offset:1024 lds
    s_mov_b64 exec, -1
    s_waitcnt vmcnt(31)
    s_barrier
    s_waitcnt vmcnt(30)
    ds_write_b16 v237, v244 offset:0
    s_waitcnt vmcnt(29)
    ds_write_b16 v237, v245 offset:10240
    s_cmp_lt_u32 s44, 2
    s_cselect_b64 exec, -1, 0
    s_waitcnt vmcnt(28)
    ds_write_b16 v237, v246 offset:20480
    s_mov_b64 exec, -1
    s_waitcnt vmcnt(21)
    ds_read_b128 a[0:3], v216 offset:0
    ds_read_b128 a[4:7], v218 offset:0
    ds_read_b128 a[8:11], v216 offset:8192
    ds_read_b128 a[12:15], v218 offset:8192
    s_waitcnt vmcnt(17)
    ds_read_b128 a[16:19], v216 offset:16384
    ds_read_b128 a[20:23], v218 offset:16384
    ds_read_b128 a[24:27], v216 offset:24576
    ds_read_b128 a[28:31], v218 offset:24576
    s_waitcnt lgkmcnt(8)
    s_barrier
    ds_read_b64_tr_b16 a[80:81], v236 offset:0
    ds_read_b64_tr_b16 a[82:83], v236 offset:160
    ds_read_b64_tr_b16 a[84:85], v236 offset:1280
    ds_read_b64_tr_b16 a[86:87], v236 offset:1440
    ds_read_b64_tr_b16 a[88:89], v236 offset:2560
    ds_read_b64_tr_b16 a[90:91], v236 offset:2720
    ds_read_b64_tr_b16 a[92:93], v236 offset:3840
    ds_read_b64_tr_b16 a[94:95], v236 offset:4000
    s_waitcnt lgkmcnt(6)
    v_mfma_f32_16x16x32_bf16 v[188:191], a[80:83], a[0:3], 0
    s_add_u32 m0, s63, 99328
    s_add_u32 s55, s55, 98304
    buffer_load_dwordx4 v231, s[20:23], s55 offen lds
    ds_read_b64_tr_b16 a[96:97], v236 offset:5120
    ds_read_b64_tr_b16 a[98:99], v236 offset:5280
    v_mfma_f32_16x16x32_bf16 v[192:195], a[0:3], a[80:83], 0
    s_waitcnt lgkmcnt(6)
    v_mfma_f32_16x16x32_bf16 v[188:191], a[84:87], a[4:7], v[188:191]
    ds_read_b64_tr_b16 a[100:101], v236 offset:6400
    ds_read_b64_tr_b16 a[102:103], v236 offset:6560
    v_mfma_f32_16x16x32_bf16 v[192:195], a[4:7], a[84:87], v[192:195]
    buffer_load_dwordx4 v232, s[20:23], s55 offen offset:1024 lds
    s_waitcnt lgkmcnt(6)
    v_mfma_f32_16x16x32_bf16 v[188:191], a[88:91], a[8:11], v[188:191]
    ds_read_b64_tr_b16 a[104:105], v236 offset:7680
    ds_read_b64_tr_b16 a[106:107], v236 offset:7840
    v_mfma_f32_16x16x32_bf16 v[192:195], a[8:11], a[88:91], v[192:195]
    s_waitcnt lgkmcnt(6)
    v_mfma_f32_16x16x32_bf16 v[188:191], a[92:95], a[12:15], v[188:191]
    buffer_load_dwordx4 v233, s[20:23], s55 offen offset:2048 lds
    ds_read_b64_tr_b16 a[108:109], v236 offset:8960
    ds_read_b64_tr_b16 a[110:111], v236 offset:9120
    v_mfma_f32_16x16x32_bf16 v[192:195], a[12:15], a[92:95], v[192:195]
    s_waitcnt lgkmcnt(6)
    v_mfma_f32_16x16x32_bf16 v[188:191], a[96:99], a[16:19], v[188:191]
    s_waitcnt vmcnt(16)
    ds_read_b128 a[32:35], v216 offset:32768
    ds_read_b64_tr_b16 a[112:113], v236 offset:10240
    ds_read_b64_tr_b16 a[114:115], v236 offset:10400
    v_mfma_f32_16x16x32_bf16 v[192:195], a[16:19], a[96:99], v[192:195]
    s_add_u32 m0, s69, 111616
    s_add_u32 s68, s68, 40960
    buffer_load_dwordx4 v252, s[8:11], s68 offen lds
    s_waitcnt lgkmcnt(7)
    v_mfma_f32_16x16x32_bf16 v[188:191], a[100:103], a[20:23], v[188:191]
    ds_read_b128 a[36:39], v218 offset:32768
    ds_read_b64_tr_b16 a[116:117], v236 offset:11520
    ds_read_b64_tr_b16 a[118:119], v236 offset:11680
    v_mfma_f32_16x16x32_bf16 v[192:195], a[20:23], a[100:103], v[192:195]
    s_waitcnt lgkmcnt(8)
    v_mfma_f32_16x16x32_bf16 v[188:191], a[104:107], a[24:27], v[188:191]
    s_mov_b64 exec, 0xffff
    buffer_load_dwordx4 v254, s[8:11], s68 offen offset:1024 lds
    s_mov_b64 exec, -1
    ds_read_b128 a[40:43], v217 offset:0
    ds_read_b64_tr_b16 a[120:121], v236 offset:12800
    ds_read_b64_tr_b16 a[122:123], v236 offset:12960
    v_mfma_f32_16x16x32_bf16 v[192:195], a[24:27], a[104:107], v[192:195]
    s_waitcnt lgkmcnt(9)
    v_mfma_f32_16x16x32_bf16 v[188:191], a[108:111], a[28:31], v[188:191]
    ds_read_b128 a[44:47], v219 offset:0
    ds_read_b64_tr_b16 a[124:125], v236 offset:14080
    ds_read_b64_tr_b16 a[126:127], v236 offset:14240
    v_mfma_f32_16x16x32_bf16 v[192:195], a[28:31], a[108:111], v[192:195]
    s_add_u32 m0, s63, 116736
    s_add_u32 s55, s55, 98304
    buffer_load_dwordx4 v231, s[20:23], s55 offen lds
    s_waitcnt lgkmcnt(9)
    v_mfma_f32_16x16x32_bf16 v[188:191], a[112:115], a[32:35], v[188:191]
    s_waitcnt vmcnt(15)
    ds_read_b128 a[48:51], v217 offset:8192
    ds_read_b64_tr_b16 a[128:129], v236 offset:15360
    ds_read_b64_tr_b16 a[130:131], v236 offset:15520
    v_mfma_f32_16x16x32_bf16 v[192:195], a[32:35], a[112:115], v[192:195]
    s_waitcnt lgkmcnt(9)
    v_mfma_f32_16x16x32_bf16 v[188:191], a[116:119], a[36:39], v[188:191]
    buffer_load_dwordx4 v232, s[20:23], s55 offen offset:1024 lds
    ds_read_b128 a[52:55], v219 offset:8192
    ds_read_b64_tr_b16 a[132:133], v236 offset:16640
    ds_read_b64_tr_b16 a[134:135], v236 offset:16800
    v_mfma_f32_16x16x32_bf16 v[192:195], a[36:39], a[116:119], v[192:195]
    s_waitcnt lgkmcnt(9)
    v_mfma_f32_16x16x32_bf16 v[188:191], a[120:123], a[40:43], v[188:191]
    ds_read_b128 a[56:59], v217 offset:16384
    ds_read_b64_tr_b16 a[136:137], v236 offset:17920
    ds_read_b64_tr_b16 a[138:139], v236 offset:18080
    v_mfma_f32_16x16x32_bf16 v[192:195], a[40:43], a[120:123], v[192:195]
    buffer_load_dwordx4 v233, s[20:23], s55 offen offset:2048 lds
    s_waitcnt lgkmcnt(9)
    v_mfma_f32_16x16x32_bf16 v[188:191], a[124:127], a[44:47], v[188:191]
    ds_read_b128 a[60:63], v219 offset:16384
    ds_read_b64_tr_b16 a[140:141], v236 offset:19200
    ds_read_b64_tr_b16 a[142:143], v236 offset:19360
    v_mfma_f32_16x16x32_bf16 v[192:195], a[44:47], a[124:127], v[192:195]
    s_waitcnt lgkmcnt(9)
    v_mfma_f32_16x16x32_bf16 v[188:191], a[128:131], a[48:51], v[188:191]
    s_add_u32 m0, s69, 129024
    s_add_u32 s68, s68, 40960
    buffer_load_dwordx4 v252, s[8:11], s68 offen lds
    s_waitcnt vmcnt(14)
    ds_read_b128 a[64:67], v217 offset:24576
    ds_read_b64_tr_b16 a[144:145], v236 offset:20480
    ds_read_b64_tr_b16 a[146:147], v236 offset:20640
    v_mfma_f32_16x16x32_bf16 v[192:195], a[48:51], a[128:131], v[192:195]
    s_waitcnt lgkmcnt(9)
    v_mfma_f32_16x16x32_bf16 v[188:191], a[132:135], a[52:55], v[188:191]
    ds_read_b128 a[68:71], v219 offset:24576
    ds_read_b64_tr_b16 a[148:149], v236 offset:21760
    ds_read_b64_tr_b16 a[150:151], v236 offset:21920
    v_mfma_f32_16x16x32_bf16 v[192:195], a[52:55], a[132:135], v[192:195]
    s_mov_b64 exec, 0xffff
    buffer_load_dwordx4 v254, s[8:11], s68 offen offset:1024 lds
    s_mov_b64 exec, -1
    s_waitcnt lgkmcnt(9)
    v_mfma_f32_16x16x32_bf16 v[188:191], a[136:139], a[56:59], v[188:191]
    ds_read_b128 a[72:75], v217 offset:32768
    ds_read_b64_tr_b16 a[152:153], v236 offset:23040
    ds_read_b64_tr_b16 a[154:155], v236 offset:23200
    v_mfma_f32_16x16x32_bf16 v[192:195], a[56:59], a[136:139], v[192:195]
    s_waitcnt lgkmcnt(9)
    v_mfma_f32_16x16x32_bf16 v[188:191], a[140:143], a[60:63], v[188:191]
    ds_read_b128 a[76:79], v219 offset:32768
    ds_read_b64_tr_b16 a[156:157], v236 offset:24320
    ds_read_b64_tr_b16 a[158:159], v236 offset:24480
    v_mfma_f32_16x16x32_bf16 v[192:195], a[60:63], a[140:143], v[192:195]
    s_waitcnt lgkmcnt(9)
    v_mfma_f32_16x16x32_bf16 v[188:191], a[144:147], a[64:67], v[188:191]
    v_mfma_f32_16x16x32_bf16 v[192:195], a[64:67], a[144:147], v[192:195]
    s_waitcnt lgkmcnt(6)
    v_mfma_f32_16x16x32_bf16 v[188:191], a[148:151], a[68:71], v[188:191]
    v_mfma_f32_16x16x32_bf16 v[192:195], a[68:71], a[148:151], v[192:195]
    s_waitcnt lgkmcnt(3)
    v_mfma_f32_16x16x32_bf16 v[188:191], a[152:155], a[72:75], v[188:191]
    v_mfma_f32_16x16x32_bf16 v[192:195], a[72:75], a[152:155], v[192:195]
    s_waitcnt lgkmcnt(0)
    v_mfma_f32_16x16x32_bf16 v[188:191], a[156:159], a[76:79], v[188:191]
    v_mfma_f32_16x16x32_bf16 v[192:195], a[76:79], a[156:159], v[192:195]
    s_lshl_b32 s58, s45, 1
    s_lshr_b32 s59, s44, 1
    s_add_u32 s58, s58, s59
    s_lshl_b32 s58, s58, 12
    s_nop 2
    v_mul_f32 v241, 0xbfb8aa3b, v188
    v_mul_f32 v188, 0x3ea52b5c, v188
    v_mul_f32 v189, 0x3ea52b5c, v189
    v_mul_f32 v190, 0x3ea52b5c, v190
    v_mul_f32 v191, 0x3ea52b5c, v191
    v_cvt_pk_bf16_f32 v188, v188, v189
    v_cvt_pk_bf16_f32 v189, v190, v191
    v_cvt_pk_bf16_f32 v192, v192, v193
    v_cvt_pk_bf16_f32 v193, v194, v195
    v_exp_f32_e64 v241, v241
    v_cndmask_b32 v192, v192, v242, s[66:67]
    v_cndmask_b32 v193, v193, v242, s[66:67]
    v_cndmask_b32 v188, v188, v192, s[64:65]
    v_cndmask_b32 v189, v189, v193, s[64:65]
    v_add_f32_e64 v241, 1.0, v241
    buffer_store_dwordx2 v[188:189], v240, s[40:43], s58 offen sc1
    v_rcp_f32 v241, v241
    s_lshl_b32 s58, s44, 8
    s_add_u32 s58, s58, 162304
    v_lshlrev_b32 v29, 2, v28
    v_add_u32 v29, s58, v29
    ds_write_b32 v29, v241
    s_waitcnt vmcnt(11) lgkmcnt(0)
    s_barrier
    ds_read_b64_tr_b16 a[80:81], v15 offset:0
    ds_read_b64_tr_b16 a[82:83], v15 offset:1280
    ds_read_b64_tr_b16 a[84:85], v15 offset:32
    ds_read_b64_tr_b16 a[86:87], v15 offset:1312
    s_add_u32 m0, s63, 134144
    s_add_u32 s55, s55, 98304
    buffer_load_dwordx4 v231, s[20:23], s55 offen lds
    ds_read_b64_tr_b16 a[88:89], v15 offset:64
    ds_read_b64_tr_b16 a[90:91], v15 offset:1344
    ds_read_b64_tr_b16 a[92:93], v15 offset:96
    ds_read_b64_tr_b16 a[94:95], v15 offset:1376
    buffer_load_dwordx4 v232, s[20:23], s55 offen offset:1024 lds
    ds_read_b64_tr_b16 a[96:97], v15 offset:128
    ds_read_b64_tr_b16 a[98:99], v15 offset:1408
    ds_read_b128 v[132:135], v220 offset:0
    ds_read_b64_tr_b16 v[148:149], v228 offset:0
    buffer_load_dwordx4 v233, s[20:23], s55 offen offset:2048 lds
    ds_read_b64_tr_b16 v[150:151], v228 offset:1536
    ds_read_b64_tr_b16 v[152:153], v229 offset:0
    ds_read_b64_tr_b16 v[154:155], v229 offset:1536
    ds_read_b64_tr_b16 v[156:157], v230 offset:0
    s_add_u32 m0, s69, 146432
    s_add_u32 s68, s68, 40960
    buffer_load_dwordx4 v252, s[8:11], s68 offen lds
    ds_read_b64_tr_b16 v[158:159], v230 offset:1536
    ds_read_b128 v[136:139], v222 offset:0
    ds_read_b64_tr_b16 v[160:161], v228 offset:6144
    ds_read_b64_tr_b16 v[162:163], v228 offset:7680
    s_mov_b64 exec, 0xffff
    buffer_load_dwordx4 v254, s[8:11], s68 offen offset:1024 lds
    s_mov_b64 exec, -1
    ds_read_b64_tr_b16 v[164:165], v229 offset:6144
    ds_read_b64_tr_b16 v[166:167], v229 offset:7680
    ds_read_b64_tr_b16 v[168:169], v230 offset:6144
    ds_read_b64_tr_b16 v[170:171], v230 offset:7680
    s_waitcnt vmcnt(11) lgkmcnt(0)
    s_barrier
    v_mfma_f32_16x16x32_bf16 v[196:199], a[80:83], a[0:3], 0
    ds_read_b128 v[140:143], v224 offset:0
    ds_read_b64_tr_b16 v[172:173], v228 offset:17408
    ds_read_b64_tr_b16 v[174:175], v228 offset:18944
    v_mfma_f32_32x32x16_bf16 v[84:99], v[148:151], v[132:135], 0
    ds_read_b64_tr_b16 v[176:177], v229 offset:17408
    ds_read_b64_tr_b16 v[178:179], v229 offset:18944
    ds_read_b64_tr_b16 v[180:181], v230 offset:17408
    s_add_u32 m0, s63, 81920
    s_mul_i32 s55, s49, 393216
    s_add_u32 s55, s55, s62
    buffer_load_dwordx4 v231, s[20:23], s55 offen lds
    v_mfma_f32_16x16x32_bf16 v[200:203], a[84:87], a[0:3], 0
    ds_read_b64_tr_b16 v[182:183], v230 offset:18944
    ds_read_b128 v[144:147], v226 offset:0
    ds_read_b64_tr_b16 v[184:185], v228 offset:23552
    v_mfma_f32_32x32x16_bf16 v[100:115], v[152:155], v[132:135], 0
    ds_read_b64_tr_b16 v[186:187], v228 offset:25088
    ds_read_b64_tr_b16 v[188:189], v229 offset:23552
    ds_read_b64_tr_b16 v[190:191], v229 offset:25088
    buffer_load_dwordx4 v232, s[20:23], s55 offen offset:1024 lds
    v_mfma_f32_16x16x32_bf16 v[204:207], a[88:91], a[0:3], 0
    ds_read_b64_tr_b16 v[192:193], v230 offset:23552
    ds_read_b64_tr_b16 v[194:195], v230 offset:25088
    ds_read_b64_tr_b16 a[100:101], v15 offset:17408
    v_mfma_f32_32x32x16_bf16 v[116:131], v[156:159], v[132:135], 0
    ds_read_b64_tr_b16 a[102:103], v15 offset:18688
    ds_read_b64_tr_b16 a[104:105], v15 offset:17440
    ds_read_b64_tr_b16 a[106:107], v15 offset:18720
    buffer_load_dwordx4 v233, s[20:23], s55 offen offset:2048 lds
    v_mfma_f32_16x16x32_bf16 v[208:211], a[92:95], a[0:3], 0
    ds_read_b64_tr_b16 a[108:109], v15 offset:17472
    ds_read_b64_tr_b16 a[110:111], v15 offset:18752
    ds_read_b64_tr_b16 a[112:113], v15 offset:17504
    v_mfma_f32_32x32x16_bf16 v[84:99], v[160:163], v[136:139], v[84:99]
    ds_read_b64_tr_b16 a[114:115], v15 offset:18784
    ds_read_b64_tr_b16 a[116:117], v15 offset:17536
    ds_read_b64_tr_b16 a[118:119], v15 offset:18816
    s_add_u32 m0, s69, 94208
    s_mul_i32 s68, s49, 163840
    s_add_u32 s68, s68, s61
    buffer_load_dwordx4 v252, s[8:11], s68 offen lds
    v_mfma_f32_16x16x32_bf16 v[212:215], a[96:99], a[0:3], 0
    v_mfma_f32_32x32x16_bf16 v[100:115], v[164:167], v[136:139], v[100:115]
    s_mov_b64 exec, 0xffff
    buffer_load_dwordx4 v254, s[8:11], s68 offen offset:1024 lds
    s_mov_b64 exec, -1
    v_mfma_f32_32x32x16_bf16 v[116:131], v[168:171], v[136:139], v[116:131]
    s_and_b32 s54, s44, 1
    s_lshl_b32 s54, s54, 9
    s_add_u32 s54, s54, 162496
    v_and_b32 v26, 1, v247
    v_lshlrev_b32 v26, 8, v26
    v_lshl_add_u32 v26, v250, 2, v26
    v_add_u32_e64 v26, s54, v26
    ds_read_b32 v16, v26
    s_waitcnt vmcnt(11) lgkmcnt(0)
    s_barrier
    v_mfma_f32_16x16x32_bf16 v[196:199], a[100:103], a[4:7], v[196:199]
    ds_read_b128 v[132:135], v220 offset:8192
    ds_read_b64_tr_b16 v[148:149], v228 offset:34816
    ds_read_b64_tr_b16 v[150:151], v228 offset:36352
    s_cmp_ge_u32 s70, 48
    s_cselect_b64 s[12:13], s[16:17], s[24:25]
    s_cselect_b32 s14, s18, s26
    s_cselect_b32 s56, 48, 0
    s_sub_u32 s56, s70, s56
    s_mul_i32 s56, s56, 40960
    s_mul_i32 s57, s46, 160
    s_add_u32 s60, s56, s57
    s_cmp_ge_u32 s70, 68
    s_cselect_b32 s14, 0, s14
    s_cselect_b32 s56, 2147483648, 0
    v_or_b32 v10, s56, v1
    s_mul_i32 s57, s46, 68
    s_add_u32 s57, s57, s70
    s_mul_i32 s57, s57, 5120
    s_add_u32 s79, s57, 11534336
    s_mul_i32 s57, s46, 68
    s_mul_i32 s56, s44, 12
    s_add_u32 s57, s57, s56
    s_mul_i32 s57, s57, 5120
    s_add_u32 s57, s57, 11534336
    s_add_u32 s72, s40, s57
    s_addc_u32 s73, s41, 0
    v_mfma_f32_32x32x16_bf16 v[84:99], v[172:175], v[140:143], v[84:99]
    ds_read_b64_tr_b16 v[152:153], v229 offset:34816
    ds_read_b64_tr_b16 v[154:155], v229 offset:36352
    ds_read_b64_tr_b16 v[156:157], v230 offset:34816
    s_add_u32 m0, s63, 99328
    s_add_u32 s55, s55, 98304
    buffer_load_dwordx4 v231, s[20:23], s55 offen lds
    v_mfma_f32_16x16x32_bf16 v[200:203], a[104:107], a[4:7], v[200:203]
    ds_read_b64_tr_b16 v[158:159], v230 offset:36352
    ds_read_b128 v[136:139], v222 offset:8192
    ds_read_b64_tr_b16 v[160:161], v228 offset:40960
    v_mfma_f32_32x32x16_bf16 v[100:115], v[176:179], v[140:143], v[100:115]
    ds_read_b64_tr_b16 v[162:163], v228 offset:42496
    ds_read_b64_tr_b16 v[164:165], v229 offset:40960
    ds_read_b64_tr_b16 v[166:167], v229 offset:42496
    buffer_load_dwordx4 v232, s[20:23], s55 offen offset:1024 lds
    v_mfma_f32_16x16x32_bf16 v[204:207], a[108:111], a[4:7], v[204:207]
    ds_read_b64_tr_b16 v[168:169], v230 offset:40960
    ds_read_b64_tr_b16 v[170:171], v230 offset:42496
    ds_read_b64_tr_b16 a[80:81], v15 offset:34816
    v_mfma_f32_32x32x16_bf16 v[116:131], v[180:183], v[140:143], v[116:131]
    ds_read_b64_tr_b16 a[82:83], v15 offset:36096
    ds_read_b64_tr_b16 a[84:85], v15 offset:34848
    ds_read_b64_tr_b16 a[86:87], v15 offset:36128
    buffer_load_dwordx4 v233, s[20:23], s55 offen offset:2048 lds
    v_mfma_f32_16x16x32_bf16 v[208:211], a[112:115], a[4:7], v[208:211]
    ds_read_b64_tr_b16 a[88:89], v15 offset:34880
    ds_read_b64_tr_b16 a[90:91], v15 offset:36160
    ds_read_b64_tr_b16 a[92:93], v15 offset:34912
    v_mfma_f32_32x32x16_bf16 v[84:99], v[184:187], v[144:147], v[84:99]
    ds_read_b64_tr_b16 a[94:95], v15 offset:36192
    ds_read_b64_tr_b16 a[96:97], v15 offset:34944
    ds_read_b64_tr_b16 a[98:99], v15 offset:36224
    s_add_u32 m0, s69, 111616
    s_add_u32 s68, s68, 40960
    buffer_load_dwordx4 v252, s[8:11], s68 offen lds
    v_mfma_f32_16x16x32_bf16 v[212:215], a[116:119], a[4:7], v[212:215]
    v_mfma_f32_32x32x16_bf16 v[100:115], v[188:191], v[144:147], v[100:115]
    s_mov_b64 exec, 0xffff
    buffer_load_dwordx4 v254, s[8:11], s68 offen offset:1024 lds
    s_mov_b64 exec, -1
    v_mfma_f32_32x32x16_bf16 v[116:131], v[192:195], v[144:147], v[116:131]
    s_waitcnt vmcnt(15)
    s_waitcnt vmcnt(10) lgkmcnt(0)
    s_barrier
    v_mfma_f32_16x16x32_bf16 v[196:199], a[80:83], a[8:11], v[196:199]
    ds_read_b128 v[140:143], v224 offset:8192
    ds_read_b64_tr_b16 v[172:173], v228 offset:52224
    ds_read_b64_tr_b16 v[174:175], v228 offset:53760
    v_mfma_f32_32x32x16_bf16 v[84:99], v[148:151], v[132:135], v[84:99]
    ds_read_b64_tr_b16 v[176:177], v229 offset:52224
    ds_read_b64_tr_b16 v[178:179], v229 offset:53760
    ds_read_b64_tr_b16 v[180:181], v230 offset:52224
    s_add_u32 m0, s63, 116736
    s_add_u32 s55, s55, 98304
    buffer_load_dwordx4 v231, s[20:23], s55 offen lds
    v_mfma_f32_16x16x32_bf16 v[200:203], a[84:87], a[8:11], v[200:203]
    ds_read_b64_tr_b16 v[182:183], v230 offset:53760
    ds_read_b128 v[144:147], v226 offset:8192
    ds_read_b64_tr_b16 v[184:185], v228 offset:58368
    v_mfma_f32_32x32x16_bf16 v[100:115], v[152:155], v[132:135], v[100:115]
    ds_read_b64_tr_b16 v[186:187], v228 offset:59904
    ds_read_b64_tr_b16 v[188:189], v229 offset:58368
    ds_read_b64_tr_b16 v[190:191], v229 offset:59904
    buffer_load_dwordx4 v232, s[20:23], s55 offen offset:1024 lds
    v_mfma_f32_16x16x32_bf16 v[204:207], a[88:91], a[8:11], v[204:207]
    ds_read_b64_tr_b16 v[192:193], v230 offset:58368
    ds_read_b64_tr_b16 v[194:195], v230 offset:59904
    ds_read_b64_tr_b16 a[100:101], v15 offset:52224
    v_mfma_f32_32x32x16_bf16 v[116:131], v[156:159], v[132:135], v[116:131]
    ds_read_b64_tr_b16 a[102:103], v15 offset:53504
    ds_read_b64_tr_b16 a[104:105], v15 offset:52256
    ds_read_b64_tr_b16 a[106:107], v15 offset:53536
    buffer_load_dwordx4 v233, s[20:23], s55 offen offset:2048 lds
    v_mfma_f32_16x16x32_bf16 v[208:211], a[92:95], a[8:11], v[208:211]
    ds_read_b64_tr_b16 a[108:109], v15 offset:52288
    ds_read_b64_tr_b16 a[110:111], v15 offset:53568
    ds_read_b64_tr_b16 a[112:113], v15 offset:52320
    v_mfma_f32_32x32x16_bf16 v[84:99], v[160:163], v[136:139], v[84:99]
    ds_read_b64_tr_b16 a[114:115], v15 offset:53600
    ds_read_b64_tr_b16 a[116:117], v15 offset:52352
    ds_read_b64_tr_b16 a[118:119], v15 offset:53632
    s_add_u32 m0, s69, 129024
    s_add_u32 s68, s68, 40960
    buffer_load_dwordx4 v252, s[8:11], s68 offen lds
    v_mfma_f32_16x16x32_bf16 v[212:215], a[96:99], a[8:11], v[212:215]
    v_mfma_f32_32x32x16_bf16 v[100:115], v[164:167], v[136:139], v[100:115]
    s_mov_b64 exec, 0xffff
    buffer_load_dwordx4 v254, s[8:11], s68 offen offset:1024 lds
    s_mov_b64 exec, -1
    v_mfma_f32_32x32x16_bf16 v[116:131], v[168:171], v[136:139], v[116:131]
    s_and_b32 s54, s2, 15
    s_lshl_b32 s54, s54, 4
    buffer_atomic_add v14, v0, s[36:39], s54 offen sc1
    s_waitcnt vmcnt(11) lgkmcnt(0)
    s_barrier
    v_mfma_f32_16x16x32_bf16 v[196:199], a[100:103], a[12:15], v[196:199]
    ds_read_b128 v[132:135], v220 offset:16384
    ds_read_b64_tr_b16 v[148:149], v228 offset:0
    ds_read_b64_tr_b16 v[150:151], v228 offset:1536
    v_mfma_f32_32x32x16_bf16 v[84:99], v[172:175], v[140:143], v[84:99]
    ds_read_b64_tr_b16 v[152:153], v229 offset:0
    ds_read_b64_tr_b16 v[154:155], v229 offset:1536
    ds_read_b64_tr_b16 v[156:157], v230 offset:0
    s_add_u32 m0, s63, 134144
    s_add_u32 s55, s55, 98304
    buffer_load_dwordx4 v231, s[20:23], s55 offen lds
    v_mfma_f32_16x16x32_bf16 v[200:203], a[104:107], a[12:15], v[200:203]
    ds_read_b64_tr_b16 v[158:159], v230 offset:1536
    ds_read_b128 v[136:139], v222 offset:16384
    ds_read_b64_tr_b16 v[160:161], v228 offset:6144
    v_mfma_f32_32x32x16_bf16 v[100:115], v[176:179], v[140:143], v[100:115]
    ds_read_b64_tr_b16 v[162:163], v228 offset:7680
    ds_read_b64_tr_b16 v[164:165], v229 offset:6144
    ds_read_b64_tr_b16 v[166:167], v229 offset:7680
    buffer_load_dwordx4 v232, s[20:23], s55 offen offset:1024 lds
    v_mfma_f32_16x16x32_bf16 v[204:207], a[108:111], a[12:15], v[204:207]
    ds_read_b64_tr_b16 v[168:169], v230 offset:6144
    ds_read_b64_tr_b16 v[170:171], v230 offset:7680
    ds_read_b64_tr_b16 a[80:81], v15 offset:0
    v_mfma_f32_32x32x16_bf16 v[116:131], v[180:183], v[140:143], v[116:131]
    ds_read_b64_tr_b16 a[82:83], v15 offset:1280
    ds_read_b64_tr_b16 a[84:85], v15 offset:32
    ds_read_b64_tr_b16 a[86:87], v15 offset:1312
    buffer_load_dwordx4 v233, s[20:23], s55 offen offset:2048 lds
    v_mfma_f32_16x16x32_bf16 v[208:211], a[112:115], a[12:15], v[208:211]
    ds_read_b64_tr_b16 a[88:89], v15 offset:64
    ds_read_b64_tr_b16 a[90:91], v15 offset:1344
    ds_read_b64_tr_b16 a[92:93], v15 offset:96
    v_mfma_f32_32x32x16_bf16 v[84:99], v[184:187], v[144:147], v[84:99]
    ds_read_b64_tr_b16 a[94:95], v15 offset:1376
    ds_read_b64_tr_b16 a[96:97], v15 offset:128
    ds_read_b64_tr_b16 a[98:99], v15 offset:1408
    s_add_u32 m0, s69, 146432
    s_add_u32 s68, s68, 40960
    buffer_load_dwordx4 v252, s[8:11], s68 offen lds
    v_mfma_f32_16x16x32_bf16 v[212:215], a[116:119], a[12:15], v[212:215]
    v_mfma_f32_32x32x16_bf16 v[100:115], v[188:191], v[144:147], v[100:115]
    s_mov_b64 exec, 0xffff
    buffer_load_dwordx4 v254, s[8:11], s68 offen offset:1024 lds
    s_mov_b64 exec, -1
    v_mfma_f32_32x32x16_bf16 v[116:131], v[192:195], v[144:147], v[116:131]
    s_waitcnt vmcnt(11) lgkmcnt(0)
    s_barrier
    v_mfma_f32_16x16x32_bf16 v[196:199], a[80:83], a[16:19], v[196:199]
    ds_read_b128 v[140:143], v224 offset:16384
    ds_read_b64_tr_b16 v[172:173], v228 offset:17408
    ds_read_b64_tr_b16 v[174:175], v228 offset:18944
    v_mfma_f32_32x32x16_bf16 v[84:99], v[148:151], v[132:135], v[84:99]
    ds_read_b64_tr_b16 v[176:177], v229 offset:17408
    ds_read_b64_tr_b16 v[178:179], v229 offset:18944
    ds_read_b64_tr_b16 v[180:181], v230 offset:17408
    s_add_u32 m0, s63, 81920
    s_mul_i32 s55, s50, 393216
    s_add_u32 s55, s55, s62
    buffer_load_dwordx4 v231, s[20:23], s55 offen lds
    v_mfma_f32_16x16x32_bf16 v[200:203], a[84:87], a[16:19], v[200:203]
    ds_read_b64_tr_b16 v[182:183], v230 offset:18944
    ds_read_b128 v[144:147], v226 offset:16384
    ds_read_b64_tr_b16 v[184:185], v228 offset:23552
    v_mfma_f32_32x32x16_bf16 v[100:115], v[152:155], v[132:135], v[100:115]
    ds_read_b64_tr_b16 v[186:187], v228 offset:25088
    ds_read_b64_tr_b16 v[188:189], v229 offset:23552
    ds_read_b64_tr_b16 v[190:191], v229 offset:25088
    buffer_load_dwordx4 v232, s[20:23], s55 offen offset:1024 lds
    v_mfma_f32_16x16x32_bf16 v[204:207], a[88:91], a[16:19], v[204:207]
    ds_read_b64_tr_b16 v[192:193], v230 offset:23552
    ds_read_b64_tr_b16 v[194:195], v230 offset:25088
    ds_read_b64_tr_b16 a[100:101], v15 offset:17408
    v_mfma_f32_32x32x16_bf16 v[116:131], v[156:159], v[132:135], v[116:131]
    ds_read_b64_tr_b16 a[102:103], v15 offset:18688
    ds_read_b64_tr_b16 a[104:105], v15 offset:17440
    ds_read_b64_tr_b16 a[106:107], v15 offset:18720
    buffer_load_dwordx4 v233, s[20:23], s55 offen offset:2048 lds
    v_mfma_f32_16x16x32_bf16 v[208:211], a[92:95], a[16:19], v[208:211]
    ds_read_b64_tr_b16 a[108:109], v15 offset:17472
    ds_read_b64_tr_b16 a[110:111], v15 offset:18752
    ds_read_b64_tr_b16 a[112:113], v15 offset:17504
    v_mfma_f32_32x32x16_bf16 v[84:99], v[160:163], v[136:139], v[84:99]
    ds_read_b64_tr_b16 a[114:115], v15 offset:18784
    ds_read_b64_tr_b16 a[116:117], v15 offset:17536
    ds_read_b64_tr_b16 a[118:119], v15 offset:18816
    s_add_u32 m0, s69, 94208
    s_mul_i32 s68, s50, 163840
    s_add_u32 s68, s68, s61
    buffer_load_dwordx4 v252, s[8:11], s68 offen lds
    v_mfma_f32_16x16x32_bf16 v[212:215], a[96:99], a[16:19], v[212:215]
    v_mfma_f32_32x32x16_bf16 v[100:115], v[164:167], v[136:139], v[100:115]
    s_mov_b64 exec, 0xffff
    buffer_load_dwordx4 v254, s[8:11], s68 offen offset:1024 lds
    s_mov_b64 exec, -1
    v_mfma_f32_32x32x16_bf16 v[116:131], v[168:171], v[136:139], v[116:131]
    s_waitcnt vmcnt(11) lgkmcnt(0)
    s_barrier
    v_mfma_f32_16x16x32_bf16 v[196:199], a[100:103], a[20:23], v[196:199]
    ds_read_b128 v[132:135], v220 offset:24576
    ds_read_b64_tr_b16 v[148:149], v228 offset:34816
    ds_read_b64_tr_b16 v[150:151], v228 offset:36352
    v_mfma_f32_32x32x16_bf16 v[84:99], v[172:175], v[140:143], v[84:99]
    ds_read_b64_tr_b16 v[152:153], v229 offset:34816
    ds_read_b64_tr_b16 v[154:155], v229 offset:36352
    ds_read_b64_tr_b16 v[156:157], v230 offset:34816
    s_add_u32 m0, s63, 99328
    s_add_u32 s55, s55, 98304
    buffer_load_dwordx4 v231, s[20:23], s55 offen lds
    v_mfma_f32_16x16x32_bf16 v[200:203], a[104:107], a[20:23], v[200:203]
    ds_read_b64_tr_b16 v[158:159], v230 offset:36352
    ds_read_b128 v[136:139], v222 offset:24576
    ds_read_b64_tr_b16 v[160:161], v228 offset:40960
    v_mfma_f32_32x32x16_bf16 v[100:115], v[176:179], v[140:143], v[100:115]
    ds_read_b64_tr_b16 v[162:163], v228 offset:42496
    ds_read_b64_tr_b16 v[164:165], v229 offset:40960
    ds_read_b64_tr_b16 v[166:167], v229 offset:42496
    buffer_load_dwordx4 v232, s[20:23], s55 offen offset:1024 lds
    v_mfma_f32_16x16x32_bf16 v[204:207], a[108:111], a[20:23], v[204:207]
    ds_read_b64_tr_b16 v[168:169], v230 offset:40960
    ds_read_b64_tr_b16 v[170:171], v230 offset:42496
    ds_read_b64_tr_b16 a[80:81], v15 offset:34816
    v_mfma_f32_32x32x16_bf16 v[116:131], v[180:183], v[140:143], v[116:131]
    ds_read_b64_tr_b16 a[82:83], v15 offset:36096
    ds_read_b64_tr_b16 a[84:85], v15 offset:34848
    ds_read_b64_tr_b16 a[86:87], v15 offset:36128
    buffer_load_dwordx4 v233, s[20:23], s55 offen offset:2048 lds
    v_mfma_f32_16x16x32_bf16 v[208:211], a[112:115], a[20:23], v[208:211]
    ds_read_b64_tr_b16 a[88:89], v15 offset:34880
    ds_read_b64_tr_b16 a[90:91], v15 offset:36160
    ds_read_b64_tr_b16 a[92:93], v15 offset:34912
    v_mfma_f32_32x32x16_bf16 v[84:99], v[184:187], v[144:147], v[84:99]
    ds_read_b64_tr_b16 a[94:95], v15 offset:36192
    ds_read_b64_tr_b16 a[96:97], v15 offset:34944
    ds_read_b64_tr_b16 a[98:99], v15 offset:36224
    s_add_u32 m0, s69, 111616
    s_add_u32 s68, s68, 40960
    buffer_load_dwordx4 v252, s[8:11], s68 offen lds
    v_mfma_f32_16x16x32_bf16 v[212:215], a[116:119], a[20:23], v[212:215]
    v_mfma_f32_32x32x16_bf16 v[100:115], v[188:191], v[144:147], v[100:115]
    s_mov_b64 exec, 0xffff
    buffer_load_dwordx4 v254, s[8:11], s68 offen offset:1024 lds
    s_mov_b64 exec, -1
    v_mfma_f32_32x32x16_bf16 v[116:131], v[192:195], v[144:147], v[116:131]
    s_waitcnt vmcnt(10) lgkmcnt(0)
    s_barrier
    v_mfma_f32_16x16x32_bf16 v[196:199], a[80:83], a[24:27], v[196:199]
    ds_read_b128 v[140:143], v224 offset:24576
    ds_read_b64_tr_b16 v[172:173], v228 offset:52224
    ds_read_b64_tr_b16 v[174:175], v228 offset:53760
    v_mfma_f32_32x32x16_bf16 v[84:99], v[148:151], v[132:135], v[84:99]
    ds_read_b64_tr_b16 v[176:177], v229 offset:52224
    ds_read_b64_tr_b16 v[178:179], v229 offset:53760
    ds_read_b64_tr_b16 v[180:181], v230 offset:52224
    s_add_u32 m0, s63, 116736
    s_add_u32 s55, s55, 98304
    buffer_load_dwordx4 v231, s[20:23], s55 offen lds
    v_mfma_f32_16x16x32_bf16 v[200:203], a[84:87], a[24:27], v[200:203]
    ds_read_b64_tr_b16 v[182:183], v230 offset:53760
    ds_read_b128 v[144:147], v226 offset:24576
    ds_read_b64_tr_b16 v[184:185], v228 offset:58368
    v_mfma_f32_32x32x16_bf16 v[100:115], v[152:155], v[132:135], v[100:115]
    ds_read_b64_tr_b16 v[186:187], v228 offset:59904
    ds_read_b64_tr_b16 v[188:189], v229 offset:58368
    ds_read_b64_tr_b16 v[190:191], v229 offset:59904
    buffer_load_dwordx4 v232, s[20:23], s55 offen offset:1024 lds
    v_mfma_f32_16x16x32_bf16 v[204:207], a[88:91], a[24:27], v[204:207]
    ds_read_b64_tr_b16 v[192:193], v230 offset:58368
    ds_read_b64_tr_b16 v[194:195], v230 offset:59904
    ds_read_b64_tr_b16 a[100:101], v15 offset:52224
    v_mfma_f32_32x32x16_bf16 v[116:131], v[156:159], v[132:135], v[116:131]
    ds_read_b64_tr_b16 a[102:103], v15 offset:53504
    ds_read_b64_tr_b16 a[104:105], v15 offset:52256
    ds_read_b64_tr_b16 a[106:107], v15 offset:53536
    buffer_load_dwordx4 v233, s[20:23], s55 offen offset:2048 lds
    v_mfma_f32_16x16x32_bf16 v[208:211], a[92:95], a[24:27], v[208:211]
    ds_read_b64_tr_b16 a[108:109], v15 offset:52288
    ds_read_b64_tr_b16 a[110:111], v15 offset:53568
    ds_read_b64_tr_b16 a[112:113], v15 offset:52320
    v_mfma_f32_32x32x16_bf16 v[84:99], v[160:163], v[136:139], v[84:99]
    ds_read_b64_tr_b16 a[114:115], v15 offset:53600
    ds_read_b64_tr_b16 a[116:117], v15 offset:52352
    ds_read_b64_tr_b16 a[118:119], v15 offset:53632
    s_add_u32 m0, s69, 129024
    s_add_u32 s68, s68, 40960
    buffer_load_dwordx4 v252, s[8:11], s68 offen lds
    v_mfma_f32_16x16x32_bf16 v[212:215], a[96:99], a[24:27], v[212:215]
    v_mfma_f32_32x32x16_bf16 v[100:115], v[164:167], v[136:139], v[100:115]
    s_mov_b64 exec, 0xffff
    buffer_load_dwordx4 v254, s[8:11], s68 offen offset:1024 lds
    s_mov_b64 exec, -1
    v_mfma_f32_32x32x16_bf16 v[116:131], v[168:171], v[136:139], v[116:131]
    s_waitcnt vmcnt(10) lgkmcnt(0)
    s_barrier
    v_mfma_f32_16x16x32_bf16 v[196:199], a[100:103], a[28:31], v[196:199]
    ds_read_b128 v[132:135], v220 offset:32768
    ds_read_b64_tr_b16 v[148:149], v228 offset:0
    ds_read_b64_tr_b16 v[150:151], v228 offset:1536
    v_mfma_f32_32x32x16_bf16 v[84:99], v[172:175], v[140:143], v[84:99]
    ds_read_b64_tr_b16 v[152:153], v229 offset:0
    ds_read_b64_tr_b16 v[154:155], v229 offset:1536
    ds_read_b64_tr_b16 v[156:157], v230 offset:0
    s_add_u32 m0, s63, 134144
    s_add_u32 s55, s55, 98304
    buffer_load_dwordx4 v231, s[20:23], s55 offen lds
    v_mfma_f32_16x16x32_bf16 v[200:203], a[104:107], a[28:31], v[200:203]
    ds_read_b64_tr_b16 v[158:159], v230 offset:1536
    ds_read_b128 v[136:139], v222 offset:32768
    ds_read_b64_tr_b16 v[160:161], v228 offset:6144
    v_mfma_f32_32x32x16_bf16 v[100:115], v[176:179], v[140:143], v[100:115]
    ds_read_b64_tr_b16 v[162:163], v228 offset:7680
    ds_read_b64_tr_b16 v[164:165], v229 offset:6144
    ds_read_b64_tr_b16 v[166:167], v229 offset:7680
    buffer_load_dwordx4 v232, s[20:23], s55 offen offset:1024 lds
    v_mfma_f32_16x16x32_bf16 v[204:207], a[108:111], a[28:31], v[204:207]
    ds_read_b64_tr_b16 v[168:169], v230 offset:6144
    ds_read_b64_tr_b16 v[170:171], v230 offset:7680
    ds_read_b64_tr_b16 a[80:81], v15 offset:0
    v_mfma_f32_32x32x16_bf16 v[116:131], v[180:183], v[140:143], v[116:131]
    ds_read_b64_tr_b16 a[82:83], v15 offset:1280
    ds_read_b64_tr_b16 a[84:85], v15 offset:32
    ds_read_b64_tr_b16 a[86:87], v15 offset:1312
    buffer_load_dwordx4 v233, s[20:23], s55 offen offset:2048 lds
    v_mfma_f32_16x16x32_bf16 v[208:211], a[112:115], a[28:31], v[208:211]
    ds_read_b64_tr_b16 a[88:89], v15 offset:64
    ds_read_b64_tr_b16 a[90:91], v15 offset:1344
    ds_read_b64_tr_b16 a[92:93], v15 offset:96
    v_mfma_f32_32x32x16_bf16 v[84:99], v[184:187], v[144:147], v[84:99]
    ds_read_b64_tr_b16 a[94:95], v15 offset:1376
    ds_read_b64_tr_b16 a[96:97], v15 offset:128
    ds_read_b64_tr_b16 a[98:99], v15 offset:1408
    s_add_u32 m0, s69, 146432
    s_add_u32 s68, s68, 40960
    buffer_load_dwordx4 v252, s[8:11], s68 offen lds
    v_mfma_f32_16x16x32_bf16 v[212:215], a[116:119], a[28:31], v[212:215]
    v_mfma_f32_32x32x16_bf16 v[100:115], v[188:191], v[144:147], v[100:115]
    s_mov_b64 exec, 0xffff
    buffer_load_dwordx4 v254, s[8:11], s68 offen offset:1024 lds
    s_mov_b64 exec, -1
    v_mfma_f32_32x32x16_bf16 v[116:131], v[192:195], v[144:147], v[116:131]
    s_waitcnt vmcnt(10) lgkmcnt(0)
    s_barrier
    v_mfma_f32_16x16x32_bf16 v[196:199], a[80:83], a[32:35], v[196:199]
    ds_read_b128 v[140:143], v224 offset:32768
    ds_read_b64_tr_b16 v[172:173], v228 offset:17408
    ds_read_b64_tr_b16 v[174:175], v228 offset:18944
    v_mfma_f32_32x32x16_bf16 v[84:99], v[148:151], v[132:135], v[84:99]
    ds_read_b64_tr_b16 v[176:177], v229 offset:17408
    ds_read_b64_tr_b16 v[178:179], v229 offset:18944
    ds_read_b64_tr_b16 v[180:181], v230 offset:17408
    s_add_u32 m0, s63, 81920
    s_mul_i32 s55, s51, 393216
    s_add_u32 s55, s55, s62
    buffer_load_dwordx4 v231, s[20:23], s55 offen lds
    v_mfma_f32_16x16x32_bf16 v[200:203], a[84:87], a[32:35], v[200:203]
    ds_read_b64_tr_b16 v[182:183], v230 offset:18944
    ds_read_b128 v[144:147], v226 offset:32768
    ds_read_b64_tr_b16 v[184:185], v228 offset:23552
    v_mfma_f32_32x32x16_bf16 v[100:115], v[152:155], v[132:135], v[100:115]
    ds_read_b64_tr_b16 v[186:187], v228 offset:25088
    ds_read_b64_tr_b16 v[188:189], v229 offset:23552
    ds_read_b64_tr_b16 v[190:191], v229 offset:25088
    buffer_load_dwordx4 v232, s[20:23], s55 offen offset:1024 lds
    v_mfma_f32_16x16x32_bf16 v[204:207], a[88:91], a[32:35], v[204:207]
    ds_read_b64_tr_b16 v[192:193], v230 offset:23552
    ds_read_b64_tr_b16 v[194:195], v230 offset:25088
    ds_read_b64_tr_b16 a[100:101], v15 offset:17408
    v_mfma_f32_32x32x16_bf16 v[116:131], v[156:159], v[132:135], v[116:131]
    ds_read_b64_tr_b16 a[102:103], v15 offset:18688
    ds_read_b64_tr_b16 a[104:105], v15 offset:17440
    ds_read_b64_tr_b16 a[106:107], v15 offset:18720
    buffer_load_dwordx4 v233, s[20:23], s55 offen offset:2048 lds
    v_mfma_f32_16x16x32_bf16 v[208:211], a[92:95], a[32:35], v[208:211]
    ds_read_b64_tr_b16 a[108:109], v15 offset:17472
    ds_read_b64_tr_b16 a[110:111], v15 offset:18752
    ds_read_b64_tr_b16 a[112:113], v15 offset:17504
    v_mfma_f32_32x32x16_bf16 v[84:99], v[160:163], v[136:139], v[84:99]
    ds_read_b64_tr_b16 a[114:115], v15 offset:18784
    ds_read_b64_tr_b16 a[116:117], v15 offset:17536
    ds_read_b64_tr_b16 a[118:119], v15 offset:18816
    s_add_u32 m0, s69, 94208
    s_mul_i32 s68, s51, 163840
    s_add_u32 s68, s68, s61
    buffer_load_dwordx4 v252, s[8:11], s68 offen lds
    v_mfma_f32_16x16x32_bf16 v[212:215], a[96:99], a[32:35], v[212:215]
    v_mfma_f32_32x32x16_bf16 v[100:115], v[164:167], v[136:139], v[100:115]
    s_mov_b64 exec, 0xffff
    buffer_load_dwordx4 v254, s[8:11], s68 offen offset:1024 lds
    s_mov_b64 exec, -1
    v_mfma_f32_32x32x16_bf16 v[116:131], v[168:171], v[136:139], v[116:131]
    s_waitcnt vmcnt(10) lgkmcnt(0)
    s_barrier
    v_mfma_f32_16x16x32_bf16 v[196:199], a[100:103], a[36:39], v[196:199]
    ds_read_b128 v[132:135], v221 offset:0
    ds_read_b64_tr_b16 v[148:149], v228 offset:34816
    ds_read_b64_tr_b16 v[150:151], v228 offset:36352
    v_mfma_f32_32x32x16_bf16 v[84:99], v[172:175], v[140:143], v[84:99]
    ds_read_b64_tr_b16 v[152:153], v229 offset:34816
    ds_read_b64_tr_b16 v[154:155], v229 offset:36352
    ds_read_b64_tr_b16 v[156:157], v230 offset:34816
    s_add_u32 m0, s63, 99328
    s_add_u32 s55, s55, 98304
    buffer_load_dwordx4 v231, s[20:23], s55 offen lds
    v_mfma_f32_16x16x32_bf16 v[200:203], a[104:107], a[36:39], v[200:203]
    ds_read_b64_tr_b16 v[158:159], v230 offset:36352
    ds_read_b128 v[136:139], v223 offset:0
    ds_read_b64_tr_b16 v[160:161], v228 offset:40960
    v_mfma_f32_32x32x16_bf16 v[100:115], v[176:179], v[140:143], v[100:115]
    ds_read_b64_tr_b16 v[162:163], v228 offset:42496
    ds_read_b64_tr_b16 v[164:165], v229 offset:40960
    ds_read_b64_tr_b16 v[166:167], v229 offset:42496
    buffer_load_dwordx4 v232, s[20:23], s55 offen offset:1024 lds
    v_mfma_f32_16x16x32_bf16 v[204:207], a[108:111], a[36:39], v[204:207]
    ds_read_b64_tr_b16 v[168:169], v230 offset:40960
    ds_read_b64_tr_b16 v[170:171], v230 offset:42496
    ds_read_b64_tr_b16 a[80:81], v15 offset:34816
    v_mfma_f32_32x32x16_bf16 v[116:131], v[180:183], v[140:143], v[116:131]
    ds_read_b64_tr_b16 a[82:83], v15 offset:36096
    ds_read_b64_tr_b16 a[84:85], v15 offset:34848
    ds_read_b64_tr_b16 a[86:87], v15 offset:36128
    buffer_load_dwordx4 v233, s[20:23], s55 offen offset:2048 lds
    v_mfma_f32_16x16x32_bf16 v[208:211], a[112:115], a[36:39], v[208:211]
    ds_read_b64_tr_b16 a[88:89], v15 offset:34880
    ds_read_b64_tr_b16 a[90:91], v15 offset:36160
    ds_read_b64_tr_b16 a[92:93], v15 offset:34912
    v_mfma_f32_32x32x16_bf16 v[84:99], v[184:187], v[144:147], v[84:99]
    ds_read_b64_tr_b16 a[94:95], v15 offset:36192
    ds_read_b64_tr_b16 a[96:97], v15 offset:34944
    ds_read_b64_tr_b16 a[98:99], v15 offset:36224
    s_add_u32 m0, s69, 111616
    s_add_u32 s68, s68, 40960
    buffer_load_dwordx4 v252, s[8:11], s68 offen lds
    v_mfma_f32_16x16x32_bf16 v[212:215], a[116:119], a[36:39], v[212:215]
    v_mfma_f32_32x32x16_bf16 v[100:115], v[188:191], v[144:147], v[100:115]
    s_mov_b64 exec, 0xffff
    buffer_load_dwordx4 v254, s[8:11], s68 offen offset:1024 lds
    s_mov_b64 exec, -1
    v_mfma_f32_32x32x16_bf16 v[116:131], v[192:195], v[144:147], v[116:131]
    s_waitcnt vmcnt(10) lgkmcnt(0)
    s_barrier
    v_mfma_f32_16x16x32_bf16 v[196:199], a[80:83], a[40:43], v[196:199]
    ds_read_b128 v[140:143], v225 offset:0
    ds_read_b64_tr_b16 v[172:173], v228 offset:52224
    ds_read_b64_tr_b16 v[174:175], v228 offset:53760
    v_mfma_f32_32x32x16_bf16 v[84:99], v[148:151], v[132:135], v[84:99]
    ds_read_b64_tr_b16 v[176:177], v229 offset:52224
    ds_read_b64_tr_b16 v[178:179], v229 offset:53760
    ds_read_b64_tr_b16 v[180:181], v230 offset:52224
    s_add_u32 m0, s63, 116736
    s_add_u32 s55, s55, 98304
    buffer_load_dwordx4 v231, s[20:23], s55 offen lds
    v_mfma_f32_16x16x32_bf16 v[200:203], a[84:87], a[40:43], v[200:203]
    ds_read_b64_tr_b16 v[182:183], v230 offset:53760
    ds_read_b128 v[144:147], v227 offset:0
    ds_read_b64_tr_b16 v[184:185], v228 offset:58368
    v_mfma_f32_32x32x16_bf16 v[100:115], v[152:155], v[132:135], v[100:115]
    ds_read_b64_tr_b16 v[186:187], v228 offset:59904
    ds_read_b64_tr_b16 v[188:189], v229 offset:58368
    ds_read_b64_tr_b16 v[190:191], v229 offset:59904
    buffer_load_dwordx4 v232, s[20:23], s55 offen offset:1024 lds
    v_mfma_f32_16x16x32_bf16 v[204:207], a[88:91], a[40:43], v[204:207]
    ds_read_b64_tr_b16 v[192:193], v230 offset:58368
    ds_read_b64_tr_b16 v[194:195], v230 offset:59904
    ds_read_b64_tr_b16 a[100:101], v15 offset:52224
    v_mfma_f32_32x32x16_bf16 v[116:131], v[156:159], v[132:135], v[116:131]
    ds_read_b64_tr_b16 a[102:103], v15 offset:53504
    ds_read_b64_tr_b16 a[104:105], v15 offset:52256
    ds_read_b64_tr_b16 a[106:107], v15 offset:53536
    buffer_load_dwordx4 v233, s[20:23], s55 offen offset:2048 lds
    v_mfma_f32_16x16x32_bf16 v[208:211], a[92:95], a[40:43], v[208:211]
    ds_read_b64_tr_b16 a[108:109], v15 offset:52288
    ds_read_b64_tr_b16 a[110:111], v15 offset:53568
    ds_read_b64_tr_b16 a[112:113], v15 offset:52320
    v_mfma_f32_32x32x16_bf16 v[84:99], v[160:163], v[136:139], v[84:99]
    ds_read_b64_tr_b16 a[114:115], v15 offset:53600
    ds_read_b64_tr_b16 a[116:117], v15 offset:52352
    ds_read_b64_tr_b16 a[118:119], v15 offset:53632
    s_add_u32 m0, s69, 129024
    s_add_u32 s68, s68, 40960
    buffer_load_dwordx4 v252, s[8:11], s68 offen lds
    v_mfma_f32_16x16x32_bf16 v[212:215], a[96:99], a[40:43], v[212:215]
    v_mfma_f32_32x32x16_bf16 v[100:115], v[164:167], v[136:139], v[100:115]
    s_mov_b64 exec, 0xffff
    buffer_load_dwordx4 v254, s[8:11], s68 offen offset:1024 lds
    s_mov_b64 exec, -1
    v_mfma_f32_32x32x16_bf16 v[116:131], v[168:171], v[136:139], v[116:131]
    v_and_b32 v27, 15, v28
    v_lshlrev_b32_e64 v27, 4, v27
    s_cmp_eq_u32 s44, 0
    s_cselect_b32 s54, 0, 2147483648
    v_or_b32 v27, s54, v27
    buffer_load_dword v26, v27, s[36:39], 0 offen sc1
    s_waitcnt vmcnt(11) lgkmcnt(0)
    s_barrier
    v_mfma_f32_16x16x32_bf16 v[196:199], a[100:103], a[44:47], v[196:199]
    ds_read_b128 v[132:135], v221 offset:8192
    ds_read_b64_tr_b16 v[148:149], v228 offset:0
    ds_read_b64_tr_b16 v[150:151], v228 offset:1536
    v_mfma_f32_32x32x16_bf16 v[84:99], v[172:175], v[140:143], v[84:99]
    ds_read_b64_tr_b16 v[152:153], v229 offset:0
    ds_read_b64_tr_b16 v[154:155], v229 offset:1536
    ds_read_b64_tr_b16 v[156:157], v230 offset:0
    s_add_u32 m0, s63, 134144
    s_add_u32 s55, s55, 98304
    buffer_load_dwordx4 v231, s[20:23], s55 offen lds
    v_mfma_f32_16x16x32_bf16 v[200:203], a[104:107], a[44:47], v[200:203]
    ds_read_b64_tr_b16 v[158:159], v230 offset:1536
    ds_read_b128 v[136:139], v223 offset:8192
    ds_read_b64_tr_b16 v[160:161], v228 offset:6144
    v_mfma_f32_32x32x16_bf16 v[100:115], v[176:179], v[140:143], v[100:115]
    ds_read_b64_tr_b16 v[162:163], v228 offset:7680
    ds_read_b64_tr_b16 v[164:165], v229 offset:6144
    ds_read_b64_tr_b16 v[166:167], v229 offset:7680
    buffer_load_dwordx4 v232, s[20:23], s55 offen offset:1024 lds
    v_mfma_f32_16x16x32_bf16 v[204:207], a[108:111], a[44:47], v[204:207]
    ds_read_b64_tr_b16 v[168:169], v230 offset:6144
    ds_read_b64_tr_b16 v[170:171], v230 offset:7680
    ds_read_b64_tr_b16 a[80:81], v15 offset:0
    v_mfma_f32_32x32x16_bf16 v[116:131], v[180:183], v[140:143], v[116:131]
    ds_read_b64_tr_b16 a[82:83], v15 offset:1280
    ds_read_b64_tr_b16 a[84:85], v15 offset:32
    ds_read_b64_tr_b16 a[86:87], v15 offset:1312
    buffer_load_dwordx4 v233, s[20:23], s55 offen offset:2048 lds
    v_mfma_f32_16x16x32_bf16 v[208:211], a[112:115], a[44:47], v[208:211]
    ds_read_b64_tr_b16 a[88:89], v15 offset:64
    ds_read_b64_tr_b16 a[90:91], v15 offset:1344
    ds_read_b64_tr_b16 a[92:93], v15 offset:96
    v_mfma_f32_32x32x16_bf16 v[84:99], v[184:187], v[144:147], v[84:99]
    ds_read_b64_tr_b16 a[94:95], v15 offset:1376
    ds_read_b64_tr_b16 a[96:97], v15 offset:128
    ds_read_b64_tr_b16 a[98:99], v15 offset:1408
    s_add_u32 m0, s69, 146432
    s_add_u32 s68, s68, 40960
    buffer_load_dwordx4 v252, s[8:11], s68 offen lds
    v_mfma_f32_16x16x32_bf16 v[212:215], a[116:119], a[44:47], v[212:215]
    v_mfma_f32_32x32x16_bf16 v[100:115], v[188:191], v[144:147], v[100:115]
    s_mov_b64 exec, 0xffff
    buffer_load_dwordx4 v254, s[8:11], s68 offen offset:1024 lds
    s_mov_b64 exec, -1
    v_mfma_f32_32x32x16_bf16 v[116:131], v[192:195], v[144:147], v[116:131]
    s_waitcnt vmcnt(11) lgkmcnt(0)
    s_barrier
    v_mfma_f32_16x16x32_bf16 v[196:199], a[80:83], a[48:51], v[196:199]
    ds_read_b128 v[140:143], v225 offset:8192
    ds_read_b64_tr_b16 v[172:173], v228 offset:17408
    ds_read_b64_tr_b16 v[174:175], v228 offset:18944
    v_mfma_f32_32x32x16_bf16 v[84:99], v[148:151], v[132:135], v[84:99]
    ds_read_b64_tr_b16 v[176:177], v229 offset:17408
    ds_read_b64_tr_b16 v[178:179], v229 offset:18944
    ds_read_b64_tr_b16 v[180:181], v230 offset:17408
    s_add_u32 m0, s63, 81920
    s_mul_i32 s55, s52, 393216
    s_add_u32 s55, s55, s62
    buffer_load_dwordx4 v231, s[20:23], s55 offen lds
    v_mfma_f32_16x16x32_bf16 v[200:203], a[84:87], a[48:51], v[200:203]
    ds_read_b64_tr_b16 v[182:183], v230 offset:18944
    ds_read_b128 v[144:147], v227 offset:8192
    ds_read_b64_tr_b16 v[184:185], v228 offset:23552
    v_mfma_f32_32x32x16_bf16 v[100:115], v[152:155], v[132:135], v[100:115]
    ds_read_b64_tr_b16 v[186:187], v228 offset:25088
    ds_read_b64_tr_b16 v[188:189], v229 offset:23552
    ds_read_b64_tr_b16 v[190:191], v229 offset:25088
    buffer_load_dwordx4 v232, s[20:23], s55 offen offset:1024 lds
    v_mfma_f32_16x16x32_bf16 v[204:207], a[88:91], a[48:51], v[204:207]
    ds_read_b64_tr_b16 v[192:193], v230 offset:23552
    ds_read_b64_tr_b16 v[194:195], v230 offset:25088
    ds_read_b64_tr_b16 a[100:101], v15 offset:17408
    v_mfma_f32_32x32x16_bf16 v[116:131], v[156:159], v[132:135], v[116:131]
    ds_read_b64_tr_b16 a[102:103], v15 offset:18688
    ds_read_b64_tr_b16 a[104:105], v15 offset:17440
    ds_read_b64_tr_b16 a[106:107], v15 offset:18720
    buffer_load_dwordx4 v233, s[20:23], s55 offen offset:2048 lds
    v_mfma_f32_16x16x32_bf16 v[208:211], a[92:95], a[48:51], v[208:211]
    ds_read_b64_tr_b16 a[108:109], v15 offset:17472
    ds_read_b64_tr_b16 a[110:111], v15 offset:18752
    ds_read_b64_tr_b16 a[112:113], v15 offset:17504
    v_mfma_f32_32x32x16_bf16 v[84:99], v[160:163], v[136:139], v[84:99]
    ds_read_b64_tr_b16 a[114:115], v15 offset:18784
    ds_read_b64_tr_b16 a[116:117], v15 offset:17536
    ds_read_b64_tr_b16 a[118:119], v15 offset:18816
    s_add_u32 m0, s69, 94208
    s_mul_i32 s68, s52, 163840
    s_add_u32 s68, s68, s61
    buffer_load_dwordx4 v252, s[8:11], s68 offen lds
    v_mfma_f32_16x16x32_bf16 v[212:215], a[96:99], a[48:51], v[212:215]
    v_mfma_f32_32x32x16_bf16 v[100:115], v[164:167], v[136:139], v[100:115]
    s_mov_b64 exec, 0xffff
    buffer_load_dwordx4 v254, s[8:11], s68 offen offset:1024 lds
    s_mov_b64 exec, -1
    v_mfma_f32_32x32x16_bf16 v[116:131], v[168:171], v[136:139], v[116:131]
    s_waitcnt vmcnt(11) lgkmcnt(0)
    s_barrier
    v_mfma_f32_16x16x32_bf16 v[196:199], a[100:103], a[52:55], v[196:199]
    ds_read_b128 v[132:135], v221 offset:16384
    ds_read_b64_tr_b16 v[148:149], v228 offset:34816
    ds_read_b64_tr_b16 v[150:151], v228 offset:36352
    v_mfma_f32_32x32x16_bf16 v[84:99], v[172:175], v[140:143], v[84:99]
    ds_read_b64_tr_b16 v[152:153], v229 offset:34816
    ds_read_b64_tr_b16 v[154:155], v229 offset:36352
    ds_read_b64_tr_b16 v[156:157], v230 offset:34816
    s_add_u32 m0, s63, 99328
    s_add_u32 s55, s55, 98304
    buffer_load_dwordx4 v231, s[20:23], s55 offen lds
    v_mfma_f32_16x16x32_bf16 v[200:203], a[104:107], a[52:55], v[200:203]
    ds_read_b64_tr_b16 v[158:159], v230 offset:36352
    ds_read_b128 v[136:139], v223 offset:16384
    ds_read_b64_tr_b16 v[160:161], v228 offset:40960
    v_mfma_f32_32x32x16_bf16 v[100:115], v[176:179], v[140:143], v[100:115]
    ds_read_b64_tr_b16 v[162:163], v228 offset:42496
    ds_read_b64_tr_b16 v[164:165], v229 offset:40960
    ds_read_b64_tr_b16 v[166:167], v229 offset:42496
    buffer_load_dwordx4 v232, s[20:23], s55 offen offset:1024 lds
    v_mfma_f32_16x16x32_bf16 v[204:207], a[108:111], a[52:55], v[204:207]
    ds_read_b64_tr_b16 v[168:169], v230 offset:40960
    ds_read_b64_tr_b16 v[170:171], v230 offset:42496
    ds_read_b64_tr_b16 a[80:81], v15 offset:34816
    v_mfma_f32_32x32x16_bf16 v[116:131], v[180:183], v[140:143], v[116:131]
    ds_read_b64_tr_b16 a[82:83], v15 offset:36096
    ds_read_b64_tr_b16 a[84:85], v15 offset:34848
    ds_read_b64_tr_b16 a[86:87], v15 offset:36128
    buffer_load_dwordx4 v233, s[20:23], s55 offen offset:2048 lds
    v_mfma_f32_16x16x32_bf16 v[208:211], a[112:115], a[52:55], v[208:211]
    ds_read_b64_tr_b16 a[88:89], v15 offset:34880
    ds_read_b64_tr_b16 a[90:91], v15 offset:36160
    ds_read_b64_tr_b16 a[92:93], v15 offset:34912
    v_mfma_f32_32x32x16_bf16 v[84:99], v[184:187], v[144:147], v[84:99]
    ds_read_b64_tr_b16 a[94:95], v15 offset:36192
    ds_read_b64_tr_b16 a[96:97], v15 offset:34944
    ds_read_b64_tr_b16 a[98:99], v15 offset:36224
    s_add_u32 m0, s69, 111616
    s_add_u32 s68, s68, 40960
    buffer_load_dwordx4 v252, s[8:11], s68 offen lds
    v_mfma_f32_16x16x32_bf16 v[212:215], a[116:119], a[52:55], v[212:215]
    v_mfma_f32_32x32x16_bf16 v[100:115], v[188:191], v[144:147], v[100:115]
    s_mov_b64 exec, 0xffff
    buffer_load_dwordx4 v254, s[8:11], s68 offen offset:1024 lds
    s_mov_b64 exec, -1
    v_mfma_f32_32x32x16_bf16 v[116:131], v[192:195], v[144:147], v[116:131]
    s_waitcnt vmcnt(10) lgkmcnt(0)
    s_barrier
    v_mfma_f32_16x16x32_bf16 v[196:199], a[80:83], a[56:59], v[196:199]
    ds_read_b128 v[140:143], v225 offset:16384
    ds_read_b64_tr_b16 v[172:173], v228 offset:52224
    ds_read_b64_tr_b16 v[174:175], v228 offset:53760
    v_mfma_f32_32x32x16_bf16 v[84:99], v[148:151], v[132:135], v[84:99]
    ds_read_b64_tr_b16 v[176:177], v229 offset:52224
    ds_read_b64_tr_b16 v[178:179], v229 offset:53760
    ds_read_b64_tr_b16 v[180:181], v230 offset:52224
    s_add_u32 m0, s63, 116736
    s_add_u32 s55, s55, 98304
    buffer_load_dwordx4 v231, s[20:23], s55 offen lds
    v_mfma_f32_16x16x32_bf16 v[200:203], a[84:87], a[56:59], v[200:203]
    ds_read_b64_tr_b16 v[182:183], v230 offset:53760
    ds_read_b128 v[144:147], v227 offset:16384
    ds_read_b64_tr_b16 v[184:185], v228 offset:58368
    v_mfma_f32_32x32x16_bf16 v[100:115], v[152:155], v[132:135], v[100:115]
    ds_read_b64_tr_b16 v[186:187], v228 offset:59904
    ds_read_b64_tr_b16 v[188:189], v229 offset:58368
    ds_read_b64_tr_b16 v[190:191], v229 offset:59904
    buffer_load_dwordx4 v232, s[20:23], s55 offen offset:1024 lds
    v_mfma_f32_16x16x32_bf16 v[204:207], a[88:91], a[56:59], v[204:207]
    ds_read_b64_tr_b16 v[192:193], v230 offset:58368
    ds_read_b64_tr_b16 v[194:195], v230 offset:59904
    ds_read_b64_tr_b16 a[100:101], v15 offset:52224
    v_mfma_f32_32x32x16_bf16 v[116:131], v[156:159], v[132:135], v[116:131]
    ds_read_b64_tr_b16 a[102:103], v15 offset:53504
    ds_read_b64_tr_b16 a[104:105], v15 offset:52256
    ds_read_b64_tr_b16 a[106:107], v15 offset:53536
    buffer_load_dwordx4 v233, s[20:23], s55 offen offset:2048 lds
    v_mfma_f32_16x16x32_bf16 v[208:211], a[92:95], a[56:59], v[208:211]
    ds_read_b64_tr_b16 a[108:109], v15 offset:52288
    ds_read_b64_tr_b16 a[110:111], v15 offset:53568
    ds_read_b64_tr_b16 a[112:113], v15 offset:52320
    v_mfma_f32_32x32x16_bf16 v[84:99], v[160:163], v[136:139], v[84:99]
    ds_read_b64_tr_b16 a[114:115], v15 offset:53600
    ds_read_b64_tr_b16 a[116:117], v15 offset:52352
    ds_read_b64_tr_b16 a[118:119], v15 offset:53632
    s_add_u32 m0, s69, 129024
    s_add_u32 s68, s68, 40960
    buffer_load_dwordx4 v252, s[8:11], s68 offen lds
    v_mfma_f32_16x16x32_bf16 v[212:215], a[96:99], a[56:59], v[212:215]
    v_mfma_f32_32x32x16_bf16 v[100:115], v[164:167], v[136:139], v[100:115]
    s_mov_b64 exec, 0xffff
    buffer_load_dwordx4 v254, s[8:11], s68 offen offset:1024 lds
    s_mov_b64 exec, -1
    v_mfma_f32_32x32x16_bf16 v[116:131], v[168:171], v[136:139], v[116:131]
    s_cmp_lg_u32 s44, 0
    s_cbranch_scc1 L_f1_ok
    v_cmp_gt_u32 vcc, 16, v26
    s_nop 0
    s_cbranch_vccz L_f1_ok
    s_mov_b32 s78, 0x40000
L_f1_spin:
    buffer_load_dword v26, v27, s[36:39], 0 offen sc1
    s_waitcnt vmcnt(0)
    v_cmp_gt_u32 vcc, 16, v26
    s_nop 1
    s_cbranch_vccz L_f1_ok
    s_sub_u32 s78, s78, 1
    s_cmp_lg_u32 s78, 0
    s_cbranch_scc1 L_f1_spin
L_f1_ok:
    s_waitcnt vmcnt(10) lgkmcnt(0)
    s_barrier
    v_mfma_f32_16x16x32_bf16 v[196:199], a[100:103], a[60:63], v[196:199]
    ds_read_b128 v[132:135], v221 offset:24576
    ds_read_b64_tr_b16 v[148:149], v228 offset:0
    ds_read_b64_tr_b16 v[150:151], v228 offset:1536
    v_mfma_f32_32x32x16_bf16 v[84:99], v[172:175], v[140:143], v[84:99]
    ds_read_b64_tr_b16 v[152:153], v229 offset:0
    ds_read_b64_tr_b16 v[154:155], v229 offset:1536
    ds_read_b64_tr_b16 v[156:157], v230 offset:0
    s_add_u32 m0, s63, 134144
    s_add_u32 s55, s55, 98304
    buffer_load_dwordx4 v231, s[20:23], s55 offen lds
    v_mfma_f32_16x16x32_bf16 v[200:203], a[104:107], a[60:63], v[200:203]
    ds_read_b64_tr_b16 v[158:159], v230 offset:1536
    ds_read_b128 v[136:139], v223 offset:24576
    ds_read_b64_tr_b16 v[160:161], v228 offset:6144
    v_mfma_f32_32x32x16_bf16 v[100:115], v[176:179], v[140:143], v[100:115]
    ds_read_b64_tr_b16 v[162:163], v228 offset:7680
    ds_read_b64_tr_b16 v[164:165], v229 offset:6144
    ds_read_b64_tr_b16 v[166:167], v229 offset:7680
    buffer_load_dwordx4 v232, s[20:23], s55 offen offset:1024 lds
    v_mfma_f32_16x16x32_bf16 v[204:207], a[108:111], a[60:63], v[204:207]
    ds_read_b64_tr_b16 v[168:169], v230 offset:6144
    ds_read_b64_tr_b16 v[170:171], v230 offset:7680
    ds_read_b64_tr_b16 a[80:81], v15 offset:0
    v_mfma_f32_32x32x16_bf16 v[116:131], v[180:183], v[140:143], v[116:131]
    ds_read_b64_tr_b16 a[82:83], v15 offset:1280
    ds_read_b64_tr_b16 a[84:85], v15 offset:32
    ds_read_b64_tr_b16 a[86:87], v15 offset:1312
    buffer_load_dwordx4 v233, s[20:23], s55 offen offset:2048 lds
    v_mfma_f32_16x16x32_bf16 v[208:211], a[112:115], a[60:63], v[208:211]
    ds_read_b64_tr_b16 a[88:89], v15 offset:64
    ds_read_b64_tr_b16 a[90:91], v15 offset:1344
    ds_read_b64_tr_b16 a[92:93], v15 offset:96
    v_mfma_f32_32x32x16_bf16 v[84:99], v[184:187], v[144:147], v[84:99]
    ds_read_b64_tr_b16 a[94:95], v15 offset:1376
    ds_read_b64_tr_b16 a[96:97], v15 offset:128
    ds_read_b64_tr_b16 a[98:99], v15 offset:1408
    s_add_u32 m0, s69, 146432
    s_add_u32 s68, s68, 40960
    buffer_load_dwordx4 v252, s[8:11], s68 offen lds
    v_mfma_f32_16x16x32_bf16 v[212:215], a[116:119], a[60:63], v[212:215]
    v_mfma_f32_32x32x16_bf16 v[100:115], v[188:191], v[144:147], v[100:115]
    s_mov_b64 exec, 0xffff
    buffer_load_dwordx4 v254, s[8:11], s68 offen offset:1024 lds
    s_mov_b64 exec, -1
    v_mfma_f32_32x32x16_bf16 v[116:131], v[192:195], v[144:147], v[116:131]
    s_waitcnt vmcnt(10) lgkmcnt(0)
    s_barrier
    v_mfma_f32_16x16x32_bf16 v[196:199], a[80:83], a[64:67], v[196:199]
    ds_read_b128 v[140:143], v225 offset:24576
    ds_read_b64_tr_b16 v[172:173], v228 offset:17408
    ds_read_b64_tr_b16 v[174:175], v228 offset:18944
    v_mfma_f32_32x32x16_bf16 v[84:99], v[148:151], v[132:135], v[84:99]
    ds_read_b64_tr_b16 v[176:177], v229 offset:17408
    ds_read_b64_tr_b16 v[178:179], v229 offset:18944
    ds_read_b64_tr_b16 v[180:181], v230 offset:17408
    global_load_dwordx4 v[56:59], v1, s[28:29] offset:-4096 sc1
    global_load_dwordx2 v[68:69], v4, s[28:29] offset:-1536 sc1
    v_mfma_f32_16x16x32_bf16 v[200:203], a[84:87], a[64:67], v[200:203]
    ds_read_b64_tr_b16 v[182:183], v230 offset:18944
    ds_read_b128 v[144:147], v227 offset:24576
    ds_read_b64_tr_b16 v[184:185], v228 offset:23552
    v_mfma_f32_32x32x16_bf16 v[100:115], v[152:155], v[132:135], v[100:115]
    ds_read_b64_tr_b16 v[186:187], v228 offset:25088
    ds_read_b64_tr_b16 v[188:189], v229 offset:23552
    ds_read_b64_tr_b16 v[190:191], v229 offset:25088
    global_load_dwordx4 v[60:63], v3, s[28:29] offset:-3072 sc1
    global_load_dwordx4 v[64:67], v3, s[28:29] offset:-2304 sc1
    v_mfma_f32_16x16x32_bf16 v[204:207], a[88:91], a[64:67], v[204:207]
    ds_read_b64_tr_b16 v[192:193], v230 offset:23552
    ds_read_b64_tr_b16 v[194:195], v230 offset:25088
    ds_read_b64_tr_b16 a[100:101], v15 offset:17408
    v_mfma_f32_32x32x16_bf16 v[116:131], v[156:159], v[132:135], v[116:131]
    ds_read_b64_tr_b16 a[102:103], v15 offset:18688
    ds_read_b64_tr_b16 a[104:105], v15 offset:17440
    ds_read_b64_tr_b16 a[106:107], v15 offset:18720
    v_mfma_f32_16x16x32_bf16 v[208:211], a[92:95], a[64:67], v[208:211]
    ds_read_b64_tr_b16 a[108:109], v15 offset:17472
    ds_read_b64_tr_b16 a[110:111], v15 offset:18752
    ds_read_b64_tr_b16 a[112:113], v15 offset:17504
    v_mfma_f32_32x32x16_bf16 v[84:99], v[160:163], v[136:139], v[84:99]
    ds_read_b64_tr_b16 a[114:115], v15 offset:18784
    ds_read_b64_tr_b16 a[116:117], v15 offset:17536
    ds_read_b64_tr_b16 a[118:119], v15 offset:18816
    v_mfma_f32_16x16x32_bf16 v[212:215], a[96:99], a[64:67], v[212:215]
    v_mfma_f32_32x32x16_bf16 v[100:115], v[164:167], v[136:139], v[100:115]
    v_mfma_f32_32x32x16_bf16 v[116:131], v[168:171], v[136:139], v[116:131]
    s_waitcnt vmcnt(9) lgkmcnt(0)
    s_barrier
    v_mfma_f32_16x16x32_bf16 v[196:199], a[100:103], a[68:71], v[196:199]
    ds_read_b128 v[132:135], v221 offset:32768
    ds_read_b64_tr_b16 v[148:149], v228 offset:34816
    ds_read_b64_tr_b16 v[150:151], v228 offset:36352
    v_mfma_f32_32x32x16_bf16 v[84:99], v[172:175], v[140:143], v[84:99]
    ds_read_b64_tr_b16 v[152:153], v229 offset:34816
    ds_read_b64_tr_b16 v[154:155], v229 offset:36352
    ds_read_b64_tr_b16 v[156:157], v230 offset:34816
    global_load_dwordx4 v[70:73], v1, s[28:29] offset:0 sc1
    global_load_dwordx2 v[82:83], v4, s[28:29] offset:2560 sc1
    v_mfma_f32_16x16x32_bf16 v[200:203], a[104:107], a[68:71], v[200:203]
    ds_read_b64_tr_b16 v[158:159], v230 offset:36352
    ds_read_b128 v[136:139], v223 offset:32768
    ds_read_b64_tr_b16 v[160:161], v228 offset:40960
    v_mfma_f32_32x32x16_bf16 v[100:115], v[176:179], v[140:143], v[100:115]
    ds_read_b64_tr_b16 v[162:163], v228 offset:42496
    ds_read_b64_tr_b16 v[164:165], v229 offset:40960
    ds_read_b64_tr_b16 v[166:167], v229 offset:42496
    global_load_dwordx4 v[74:77], v3, s[28:29] offset:1024 sc1
    global_load_dwordx4 v[78:81], v3, s[28:29] offset:1792 sc1
    s_add_u32 s28, s28, 8192
    s_addc_u32 s29, s29, 0
    v_mfma_f32_16x16x32_bf16 v[204:207], a[108:111], a[68:71], v[204:207]
    ds_read_b64_tr_b16 v[168:169], v230 offset:40960
    ds_read_b64_tr_b16 v[170:171], v230 offset:42496
    ds_read_b64_tr_b16 a[80:81], v15 offset:34816
    v_mfma_f32_32x32x16_bf16 v[116:131], v[180:183], v[140:143], v[116:131]
    ds_read_b64_tr_b16 a[82:83], v15 offset:36096
    ds_read_b64_tr_b16 a[84:85], v15 offset:34848
    ds_read_b64_tr_b16 a[86:87], v15 offset:36128
    v_mfma_f32_16x16x32_bf16 v[208:211], a[112:115], a[68:71], v[208:211]
    ds_read_b64_tr_b16 a[88:89], v15 offset:34880
    ds_read_b64_tr_b16 a[90:91], v15 offset:36160
    ds_read_b64_tr_b16 a[92:93], v15 offset:34912
    v_mfma_f32_32x32x16_bf16 v[84:99], v[184:187], v[144:147], v[84:99]
    ds_read_b64_tr_b16 a[94:95], v15 offset:36192
    ds_read_b64_tr_b16 a[96:97], v15 offset:34944
    ds_read_b64_tr_b16 a[98:99], v15 offset:36224
    v_mfma_f32_16x16x32_bf16 v[212:215], a[116:119], a[68:71], v[212:215]
    v_mfma_f32_32x32x16_bf16 v[100:115], v[188:191], v[144:147], v[100:115]
    v_mfma_f32_32x32x16_bf16 v[116:131], v[192:195], v[144:147], v[116:131]
    s_waitcnt vmcnt(8) lgkmcnt(0)
    s_barrier
    v_mfma_f32_16x16x32_bf16 v[196:199], a[80:83], a[72:75], v[196:199]
    ds_read_b128 v[140:143], v225 offset:32768
    ds_read_b64_tr_b16 v[172:173], v228 offset:52224
    ds_read_b64_tr_b16 v[174:175], v228 offset:53760
    v_mfma_f32_32x32x16_bf16 v[84:99], v[148:151], v[132:135], v[84:99]
    ds_read_b64_tr_b16 v[176:177], v229 offset:52224
    ds_read_b64_tr_b16 v[178:179], v229 offset:53760
    ds_read_b64_tr_b16 v[180:181], v230 offset:52224
    s_mul_i32 s54, s44, 6144
    s_add_u32 s54, s54, 122880
    v_add_u32_e64 v252, s54, v1
    s_xor_b32 s54, s44, 2
    s_mul_i32 s54, s54, 6144
    s_add_u32 s54, s54, 122880
    v_add_u32 v254, s54, v1
    s_lshl_b32 s54, s44, 10
    s_add_u32 s54, s54, 147456
    v_add_u32_e64 v253, s54, v1
    v_and_b32 v255, 0x1f0, v1
    v_and_b32 v29, 0x200, v1
    v_lshl_add_u32 v255, v29, 1, v255
    v_add_u32 v255, 147968, v255
    v_mfma_f32_16x16x32_bf16 v[200:203], a[84:87], a[72:75], v[200:203]
    ds_read_b64_tr_b16 v[182:183], v230 offset:53760
    ds_read_b128 v[144:147], v227 offset:32768
    ds_read_b64_tr_b16 v[184:185], v228 offset:58368
    v_mfma_f32_32x32x16_bf16 v[100:115], v[152:155], v[132:135], v[100:115]
    ds_read_b64_tr_b16 v[186:187], v228 offset:59904
    ds_read_b64_tr_b16 v[188:189], v229 offset:58368
    ds_read_b64_tr_b16 v[190:191], v229 offset:59904
    global_load_dwordx4 a[160:163], v1, s[28:29] offset:-4096 sc1
    global_load_dwordx2 a[172:173], v4, s[28:29] offset:-1536 sc1
    v_mfma_f32_16x16x32_bf16 v[204:207], a[88:91], a[72:75], v[204:207]
    ds_read_b64_tr_b16 v[192:193], v230 offset:58368
    ds_read_b64_tr_b16 v[194:195], v230 offset:59904
    ds_read_b64_tr_b16 a[100:101], v15 offset:52224
    v_mfma_f32_32x32x16_bf16 v[116:131], v[156:159], v[132:135], v[116:131]
    ds_read_b64_tr_b16 a[102:103], v15 offset:53504
    ds_read_b64_tr_b16 a[104:105], v15 offset:52256
    ds_read_b64_tr_b16 a[106:107], v15 offset:53536
    global_load_dwordx4 a[164:167], v3, s[28:29] offset:-3072 sc1
    global_load_dwordx4 a[168:171], v3, s[28:29] offset:-2304 sc1
    v_mfma_f32_16x16x32_bf16 v[208:211], a[92:95], a[72:75], v[208:211]
    ds_read_b64_tr_b16 a[108:109], v15 offset:52288
    ds_read_b64_tr_b16 a[110:111], v15 offset:53568
    ds_read_b64_tr_b16 a[112:113], v15 offset:52320
    v_mfma_f32_32x32x16_bf16 v[84:99], v[160:163], v[136:139], v[84:99]
    ds_read_b64_tr_b16 a[114:115], v15 offset:53600
    ds_read_b64_tr_b16 a[116:117], v15 offset:52352
    ds_read_b64_tr_b16 a[118:119], v15 offset:53632
    v_mfma_f32_16x16x32_bf16 v[212:215], a[96:99], a[72:75], v[212:215]
    v_mfma_f32_32x32x16_bf16 v[100:115], v[164:167], v[136:139], v[100:115]
    v_mfma_f32_32x32x16_bf16 v[116:131], v[168:171], v[136:139], v[116:131]
    s_waitcnt lgkmcnt(0)
    s_barrier
    v_mfma_f32_16x16x32_bf16 v[196:199], a[100:103], a[76:79], v[196:199]
    v_mfma_f32_16x16x32_bf16 v[200:203], a[104:107], a[76:79], v[200:203]
    v_mfma_f32_16x16x32_bf16 v[204:207], a[108:111], a[76:79], v[204:207]
    v_mfma_f32_16x16x32_bf16 v[208:211], a[112:115], a[76:79], v[208:211]
    v_mfma_f32_16x16x32_bf16 v[212:215], a[116:119], a[76:79], v[212:215]
    v_mfma_f32_32x32x16_bf16 v[84:99], v[172:175], v[140:143], v[84:99]
    global_load_dwordx4 a[174:177], v1, s[28:29] offset:0 sc1
    global_load_dwordx2 a[186:187], v4, s[28:29] offset:2560 sc1
    v_mfma_f32_32x32x16_bf16 v[100:115], v[176:179], v[140:143], v[100:115]
    global_load_dwordx4 a[178:181], v3, s[28:29] offset:1024 sc1
    global_load_dwordx4 a[182:185], v3, s[28:29] offset:1792 sc1
    s_add_u32 s28, s28, 8192
    s_addc_u32 s29, s29, 0
    v_mfma_f32_32x32x16_bf16 v[116:131], v[180:183], v[140:143], v[116:131]
    s_mul_i32 s54, s44, 5120
    s_add_u32 m0, s54, 0
    s_add_u32 s54, s54, 1024
    buffer_load_dwordx4 v5, s[12:15], s60 offen lds
    v_cvt_pk_bf16_f32 v196, v196, v197
    v_cvt_pk_bf16_f32 v197, v198, v199
    ds_write_b64 v238, v[196:197] offset:0
    v_cvt_pk_bf16_f32 v200, v200, v201
    v_cvt_pk_bf16_f32 v201, v202, v203
    ds_write_b64 v238, v[200:201] offset:32
    v_cvt_pk_bf16_f32 v204, v204, v205
    v_cvt_pk_bf16_f32 v205, v206, v207
    ds_write_b64 v238, v[204:205] offset:64
    v_cvt_pk_bf16_f32 v208, v208, v209
    v_cvt_pk_bf16_f32 v209, v210, v211
    ds_write_b64 v238, v[208:209] offset:96
    v_cvt_pk_bf16_f32 v212, v212, v213
    v_cvt_pk_bf16_f32 v213, v214, v215
    ds_write_b64 v238, v[212:213] offset:128
    v_mfma_f32_32x32x16_bf16 v[84:99], v[184:187], v[144:147], v[84:99]
    buffer_load_dwordx4 v6, s[12:15], s60 offen offset:1024 lds
    v_mfma_f32_32x32x16_bf16 v[100:115], v[188:191], v[144:147], v[100:115]
    buffer_load_dwordx4 v7, s[12:15], s60 offen offset:2048 lds
    v_mfma_f32_32x32x16_bf16 v[116:131], v[192:195], v[144:147], v[116:131]
    buffer_load_dwordx4 v8, s[12:15], s60 offen offset:3072 lds
    s_mov_b32 m0, s54
    s_nop 0
    buffer_load_dwordx4 v9, s[12:15], s60 offen offset:3072 lds
    s_lshr_b32 s58, s44, 1
    s_mul_i32 s58, s58, 80
    v_lshrrev_b32 v29, 5, v28
    v_lshl_add_u32 v29, v29, 4, v239
    v_add_u32 v30, s58, v29
    v_subrev_u32 v29, s58, v29
    v_add_u32 v31, s58, v239
    v_subrev_u32 v239, s58, v239
    s_waitcnt lgkmcnt(0)
    s_barrier
    ds_read_b64 v[32:33], v30 offset:0
    ds_read_b64 v[34:35], v30 offset:8
    ds_read_b64 v[38:39], v30 offset:40
    ds_read_b64 v[40:41], v30 offset:48
    ds_read_b64 v[44:45], v29 offset:80
    ds_read_b64 v[46:47], v29 offset:88
    ds_read_b64 v[50:51], v29 offset:120
    ds_read_b64 v[52:53], v29 offset:128
    s_mov_b64 exec, 0xffffffff
    ds_read_b64 v[36:37], v31 offset:32
    ds_read_b64 v[42:43], v31 offset:72
    ds_read_b64 v[48:49], v239 offset:112
    ds_read_b64 v[54:55], v239 offset:152
    s_mov_b64 exec, -1
    s_mul_i32 s58, s46, 6
    s_lshr_b32 s59, s44, 1
    s_mul_i32 s59, s59, 3
    s_add_u32 s58, s58, s59
    s_lshl_b32 s58, s58, 12
    s_and_b32 s59, s44, 1
    s_lshl_b32 s59, s59, 11
    s_add_u32 s58, s58, s59
    s_add_u32 s58, s58, s71
    v_sub_f32_e64 v220, 1.0, v16
    s_mul_i32 s59, s44, 5120
    s_sub_u32 s59, s59, 94208
    v_add_u32_e64 v15, s59, v15
    s_add_u32 s58, s58, 4096
    s_add_u32 s52, s40, s58
    s_addc_u32 s53, s41, 0
    v_pk_mul_f32 v[84:85], v[84:85], v[220:221] op_sel_hi:[1,0]
    v_pk_mul_f32 v[86:87], v[86:87], v[220:221] op_sel_hi:[1,0]
    v_pk_mul_f32 v[88:89], v[88:89], v[220:221] op_sel_hi:[1,0]
    v_pk_mul_f32 v[90:91], v[90:91], v[220:221] op_sel_hi:[1,0]
    v_cvt_pk_bf16_f32 v132, v84, v85
    v_cvt_pk_bf16_f32 v133, v86, v87
    v_cvt_pk_bf16_f32 v134, v88, v89
    v_cvt_pk_bf16_f32 v135, v90, v91
    v_pk_max_i16 v132, v132, 0
    v_pk_max_i16 v133, v133, 0
    v_pk_max_i16 v134, v134, 0
    v_pk_max_i16 v135, v135, 0
    v_pk_mul_f32 v[92:93], v[92:93], v[220:221] op_sel_hi:[1,0]
    v_pk_mul_f32 v[94:95], v[94:95], v[220:221] op_sel_hi:[1,0]
    v_pk_mul_f32 v[96:97], v[96:97], v[220:221] op_sel_hi:[1,0]
    v_pk_mul_f32 v[98:99], v[98:99], v[220:221] op_sel_hi:[1,0]
    v_cvt_pk_bf16_f32 v136, v92, v93
    v_cvt_pk_bf16_f32 v137, v94, v95
    v_cvt_pk_bf16_f32 v138, v96, v97
    v_cvt_pk_bf16_f32 v139, v98, v99
    v_pk_max_i16 v136, v136, 0
    v_pk_max_i16 v137, v137, 0
    v_pk_max_i16 v138, v138, 0
    v_pk_max_i16 v139, v139, 0
    s_waitcnt vmcnt(20) lgkmcnt(10)
    v_mfma_f32_32x32x16_bf16 v[84:99], v[56:59], v[32:35], 0
    v_pk_mul_f32 v[100:101], v[100:101], v[220:221] op_sel_hi:[1,0]
    v_pk_mul_f32 v[102:103], v[102:103], v[220:221] op_sel_hi:[1,0]
    v_pk_mul_f32 v[104:105], v[104:105], v[220:221] op_sel_hi:[1,0]
    v_pk_mul_f32 v[106:107], v[106:107], v[220:221] op_sel_hi:[1,0]
    v_cvt_pk_bf16_f32 v140, v100, v101
    v_cvt_pk_bf16_f32 v141, v102, v103
    v_cvt_pk_bf16_f32 v142, v104, v105
    v_cvt_pk_bf16_f32 v143, v106, v107
    v_pk_max_i16 v140, v140, 0
    v_pk_max_i16 v141, v141, 0
    v_pk_max_i16 v142, v142, 0
    v_pk_max_i16 v143, v143, 0
    s_waitcnt vmcnt(19) lgkmcnt(3)
    v_mfma_f32_32x32x8_bf16 v[84:99], v[68:69], v[36:37], v[84:99]
    v_pk_mul_f32 v[108:109], v[108:109], v[220:221] op_sel_hi:[1,0]
    v_pk_mul_f32 v[110:111], v[110:111], v[220:221] op_sel_hi:[1,0]
    v_pk_mul_f32 v[112:113], v[112:113], v[220:221] op_sel_hi:[1,0]
    v_pk_mul_f32 v[114:115], v[114:115], v[220:221] op_sel_hi:[1,0]
    v_cvt_pk_bf16_f32 v144, v108, v109
    v_cvt_pk_bf16_f32 v145, v110, v111
    v_cvt_pk_bf16_f32 v146, v112, v113
    v_cvt_pk_bf16_f32 v147, v114, v115
    v_pk_max_i16 v144, v144, 0
    v_pk_max_i16 v145, v145, 0
    v_pk_max_i16 v146, v146, 0
    v_pk_max_i16 v147, v147, 0
    v_pk_mul_f32 v[116:117], v[116:117], v[220:221] op_sel_hi:[1,0]
    v_pk_mul_f32 v[118:119], v[118:119], v[220:221] op_sel_hi:[1,0]
    v_pk_mul_f32 v[120:121], v[120:121], v[220:221] op_sel_hi:[1,0]
    v_pk_mul_f32 v[122:123], v[122:123], v[220:221] op_sel_hi:[1,0]
    v_cvt_pk_bf16_f32 v148, v116, v117
    v_cvt_pk_bf16_f32 v149, v118, v119
    v_cvt_pk_bf16_f32 v150, v120, v121
    v_cvt_pk_bf16_f32 v151, v122, v123
    v_pk_max_i16 v148, v148, 0
    v_pk_max_i16 v149, v149, 0
    v_pk_max_i16 v150, v150, 0
    v_pk_max_i16 v151, v151, 0
    v_pk_mul_f32 v[124:125], v[124:125], v[220:221] op_sel_hi:[1,0]
    v_pk_mul_f32 v[126:127], v[126:127], v[220:221] op_sel_hi:[1,0]
    v_pk_mul_f32 v[128:129], v[128:129], v[220:221] op_sel_hi:[1,0]
    v_pk_mul_f32 v[130:131], v[130:131], v[220:221] op_sel_hi:[1,0]
    v_cvt_pk_bf16_f32 v152, v124, v125
    v_cvt_pk_bf16_f32 v153, v126, v127
    v_cvt_pk_bf16_f32 v154, v128, v129
    v_cvt_pk_bf16_f32 v155, v130, v131
    v_pk_max_i16 v152, v152, 0
    v_pk_max_i16 v153, v153, 0
    v_pk_max_i16 v154, v154, 0
    v_pk_max_i16 v155, v155, 0
    v_mfma_f32_32x32x16_bf16 v[100:115], v[56:59], v[38:41], 0
    v_exp_f32 v84, v84
    v_exp_f32 v85, v85
    v_exp_f32 v86, v86
    v_exp_f32_e64 v87, v87
    s_waitcnt lgkmcnt(2)
    v_mfma_f32_32x32x8_bf16 v[100:115], v[68:69], v[42:43], v[100:115]
    v_exp_f32 v88, v88
    v_exp_f32 v89, v89
    v_exp_f32 v90, v90
    v_exp_f32 v91, v91
    global_store_dwordx4 v243, v[132:135], s[52:53] offset:-4096 sc1
    v_exp_f32 v92, v92
    v_exp_f32 v93, v93
    v_exp_f32 v94, v94
    v_exp_f32 v95, v95
    global_store_dwordx4 v243, v[136:139], s[52:53] offset:-3584 sc1
    v_exp_f32 v96, v96
    v_exp_f32 v97, v97
    v_exp_f32 v98, v98
    v_exp_f32 v99, v99
    v_mfma_f32_32x32x16_bf16 v[116:131], v[56:59], v[44:47], 0
    global_store_dwordx4 v243, v[140:143], s[52:53] offset:0 sc1
    v_exp_f32 v100, v100
    v_exp_f32 v101, v101
    v_exp_f32 v102, v102
    v_exp_f32_e64 v103, v103
    s_waitcnt lgkmcnt(1)
    v_mfma_f32_32x32x8_bf16 v[116:131], v[68:69], v[48:49], v[116:131]
    v_exp_f32 v104, v104
    v_exp_f32 v105, v105
    v_exp_f32 v106, v106
    v_exp_f32_e64 v107, v107
    s_waitcnt vmcnt(21)
    v_smfmac_f32_32x32x32_bf16 a[192:207], v[60:63], v[84:91], v2
    s_waitcnt vmcnt(16)
    v_exp_f32 v108, v108
    v_exp_f32 v109, v109
    v_exp_f32 v110, v110
    v_exp_f32_e64 v111, v111
    v_smfmac_f32_32x32x32_bf16 a[192:207], v[64:67], v[92:99], v2
    global_store_dwordx4 v243, v[144:147], s[52:53] offset:512 sc1
    v_exp_f32 v112, v112
    v_exp_f32 v113, v113
    v_exp_f32 v114, v114
    v_exp_f32 v115, v115
    v_mfma_f32_32x32x16_bf16 v[84:99], v[56:59], v[50:53], 0
    v_exp_f32 v116, v116
    v_exp_f32 v117, v117
    v_exp_f32 v118, v118
    v_exp_f32_e64 v119, v119
    s_waitcnt lgkmcnt(0)
    v_mfma_f32_32x32x8_bf16 v[84:99], v[68:69], v[54:55], v[84:99]
    v_exp_f32 v120, v120
    v_exp_f32 v121, v121
    v_exp_f32 v122, v122
    v_exp_f32 v123, v123
    v_smfmac_f32_32x32x32_bf16 a[208:223], v[60:63], v[100:107], v2
    global_load_dwordx4 v[56:59], v1, s[28:29] offset:-4096 sc1
    v_exp_f32 v124, v124
    v_exp_f32 v125, v125
    v_exp_f32 v126, v126
    v_exp_f32 v127, v127
    v_smfmac_f32_32x32x32_bf16 a[208:223], v[64:67], v[108:115], v2
    s_add_u32 s52, s52, 4096
    s_addc_u32 s53, s53, 0
    v_exp_f32 v128, v128
    v_exp_f32 v129, v129
    v_exp_f32 v130, v130
    v_exp_f32_e64 v131, v131
    v_mfma_f32_32x32x16_bf16 v[100:115], v[70:73], v[32:35], 0
    global_store_dwordx4 v243, v[148:151], s[52:53] offset:0 sc1
    v_exp_f32 v84, v84
    v_exp_f32 v85, v85
    v_exp_f32 v86, v86
    v_exp_f32 v87, v87
    v_mfma_f32_32x32x8_bf16 v[100:115], v[82:83], v[36:37], v[100:115]
    v_exp_f32 v88, v88
    v_exp_f32 v89, v89
    v_exp_f32 v90, v90
    v_exp_f32 v91, v91
    v_smfmac_f32_32x32x32_bf16 a[224:239], v[60:63], v[116:123], v2
    global_load_dwordx2 v[68:69], v4, s[28:29] offset:-1536 sc1
    v_exp_f32 v92, v92
    v_exp_f32 v93, v93
    v_exp_f32 v94, v94
    v_exp_f32 v95, v95
    v_smfmac_f32_32x32x32_bf16 a[224:239], v[64:67], v[124:131], v2
    global_store_dwordx4 v243, v[152:155], s[52:53] offset:512 sc1
    v_exp_f32 v96, v96
    v_exp_f32 v97, v97
    v_exp_f32 v98, v98
    v_exp_f32 v99, v99
    v_mfma_f32_32x32x16_bf16 v[116:131], v[70:73], v[38:41], 0
    v_exp_f32 v100, v100
    v_exp_f32 v101, v101
    v_exp_f32 v102, v102
    v_exp_f32 v103, v103
    v_mfma_f32_32x32x8_bf16 v[116:131], v[82:83], v[42:43], v[116:131]
    v_exp_f32 v104, v104
    v_exp_f32 v105, v105
    v_exp_f32 v106, v106
    v_exp_f32 v107, v107
    v_smfmac_f32_32x32x32_bf16 a[240:255], v[60:63], v[84:91], v2
    v_exp_f32 v108, v108
    v_exp_f32 v109, v109
    v_exp_f32 v110, v110
    v_exp_f32 v111, v111
    v_smfmac_f32_32x32x32_bf16 a[240:255], v[64:67], v[92:99], v2
    global_load_dwordx4 v[60:63], v3, s[28:29] offset:-3072 sc1
    v_exp_f32 v112, v112
    v_exp_f32 v113, v113
    v_exp_f32 v114, v114
    v_exp_f32 v115, v115
    v_mfma_f32_32x32x16_bf16 v[84:99], v[70:73], v[44:47], 0
    v_exp_f32 v116, v116
    v_exp_f32 v117, v117
    v_exp_f32 v118, v118
    v_exp_f32 v119, v119
    v_mfma_f32_32x32x8_bf16 v[84:99], v[82:83], v[48:49], v[84:99]
    v_exp_f32 v120, v120
    v_exp_f32 v121, v121
    v_exp_f32 v122, v122
    v_exp_f32 v123, v123
    v_smfmac_f32_32x32x32_bf16 a[192:207], v[74:77], v[100:107], v2
    s_waitcnt vmcnt(18)
    global_load_dwordx4 v[64:67], v3, s[28:29] offset:-2304 sc1
    v_exp_f32 v124, v124
    v_exp_f32 v125, v125
    v_exp_f32 v126, v126
    v_exp_f32_e64 v127, v127
    v_smfmac_f32_32x32x32_bf16 a[192:207], v[78:81], v[108:115], v2
    v_exp_f32 v128, v128
    v_exp_f32 v129, v129
    v_exp_f32 v130, v130
    v_exp_f32 v131, v131
    v_mfma_f32_32x32x16_bf16 v[100:115], v[70:73], v[50:53], 0
    v_exp_f32 v84, v84
    v_exp_f32 v85, v85
    v_exp_f32 v86, v86
    v_exp_f32 v87, v87
    v_mfma_f32_32x32x8_bf16 v[100:115], v[82:83], v[54:55], v[100:115]
    v_exp_f32 v88, v88
    v_exp_f32 v89, v89
    v_exp_f32 v90, v90
    v_exp_f32 v91, v91
    v_smfmac_f32_32x32x32_bf16 a[208:223], v[74:77], v[116:123], v2
    global_load_dwordx4 v[70:73], v1, s[28:29] offset:0 sc1
    v_exp_f32 v92, v92
    v_exp_f32 v93, v93
    v_exp_f32 v94, v94
    v_exp_f32 v95, v95
    v_smfmac_f32_32x32x32_bf16 a[208:223], v[78:81], v[124:131], v2
    v_exp_f32 v96, v96
    v_exp_f32 v97, v97
    v_exp_f32 v98, v98
    v_exp_f32 v99, v99
    v_mfma_f32_32x32x16_bf16 v[116:131], a[160:163], v[32:35], 0
    v_exp_f32 v100, v100
    v_exp_f32 v101, v101
    v_exp_f32 v102, v102
    v_exp_f32 v103, v103
    v_mfma_f32_32x32x8_bf16 v[116:131], a[172:173], v[36:37], v[116:131]
    v_exp_f32 v104, v104
    v_exp_f32 v105, v105
    v_exp_f32 v106, v106
    v_exp_f32 v107, v107
    v_smfmac_f32_32x32x32_bf16 a[224:239], v[74:77], v[84:91], v2
    global_load_dwordx2 v[82:83], v4, s[28:29] offset:2560 sc1
    v_exp_f32 v108, v108
    v_exp_f32 v109, v109
    v_exp_f32 v110, v110
    v_exp_f32 v111, v111
    v_smfmac_f32_32x32x32_bf16 a[224:239], v[78:81], v[92:99], v2
    v_exp_f32 v112, v112
    v_exp_f32 v113, v113
    v_exp_f32 v114, v114
    v_exp_f32 v115, v115
    v_mfma_f32_32x32x16_bf16 v[84:99], a[160:163], v[38:41], 0
    s_waitcnt vmcnt(12)
    v_exp_f32 v116, v116
    v_exp_f32 v117, v117
    v_exp_f32 v118, v118
    v_exp_f32_e64 v119, v119
    v_mfma_f32_32x32x8_bf16 v[84:99], a[172:173], v[42:43], v[84:99]
    v_exp_f32 v120, v120
    v_exp_f32 v121, v121
    v_exp_f32 v122, v122
    v_exp_f32 v123, v123
    v_smfmac_f32_32x32x32_bf16 a[240:255], v[74:77], v[100:107], v2
    ds_read_b64_tr_b16 v[212:213], v15 offset:0
    v_exp_f32 v124, v124
    v_exp_f32 v125, v125
    v_exp_f32 v126, v126
    v_exp_f32 v127, v127
    v_smfmac_f32_32x32x32_bf16 a[240:255], v[78:81], v[108:115], v2
    global_load_dwordx4 v[74:77], v3, s[28:29] offset:1024 sc1
    v_exp_f32 v128, v128
    v_exp_f32 v129, v129
    v_exp_f32 v130, v130
    v_exp_f32 v131, v131
    v_mfma_f32_32x32x16_bf16 v[100:115], a[160:163], v[44:47], 0
    ds_read_b64_tr_b16 v[214:215], v15 offset:1280
    v_exp_f32 v84, v84
    v_exp_f32 v85, v85
    v_exp_f32 v86, v86
    v_exp_f32 v87, v87
    v_mfma_f32_32x32x8_bf16 v[100:115], a[172:173], v[48:49], v[100:115]
    v_exp_f32 v88, v88
    v_exp_f32 v89, v89
    v_exp_f32 v90, v90
    v_exp_f32 v91, v91
    v_smfmac_f32_32x32x32_bf16 a[192:207], a[164:167], v[116:123], v2
    global_load_dwordx4 v[78:81], v3, s[28:29] offset:1792 sc1
    v_exp_f32 v92, v92
    v_exp_f32 v93, v93
    v_exp_f32 v94, v94
    v_exp_f32 v95, v95
    v_smfmac_f32_32x32x32_bf16 a[192:207], a[168:171], v[124:131], v2
    s_add_u32 s28, s28, 8192
    s_addc_u32 s29, s29, 0
    v_exp_f32 v96, v96
    v_exp_f32 v97, v97
    v_exp_f32 v98, v98
    v_exp_f32_e64 v99, v99
    v_mfma_f32_32x32x16_bf16 v[116:131], a[160:163], v[50:53], 0
    ds_read_b64_tr_b16 v[216:217], v15 offset:32
    v_exp_f32 v100, v100
    v_exp_f32 v101, v101
    v_exp_f32 v102, v102
    v_exp_f32 v103, v103
    v_mfma_f32_32x32x8_bf16 v[116:131], a[172:173], v[54:55], v[116:131]
    v_exp_f32 v104, v104
    v_exp_f32 v105, v105
    v_exp_f32 v106, v106
    v_exp_f32 v107, v107
    v_smfmac_f32_32x32x32_bf16 a[208:223], a[164:167], v[84:91], v2
    global_load_dwordx4 a[160:163], v1, s[28:29] offset:-4096 sc1
    v_exp_f32 v108, v108
    v_exp_f32 v109, v109
    v_exp_f32 v110, v110
    v_exp_f32 v111, v111
    v_smfmac_f32_32x32x32_bf16 a[208:223], a[168:171], v[92:99], v2
    ds_read_b64_tr_b16 v[218:219], v15 offset:1312
    v_exp_f32 v112, v112
    v_exp_f32 v113, v113
    v_exp_f32 v114, v114
    v_exp_f32 v115, v115
    v_mfma_f32_32x32x16_bf16 v[84:99], a[174:177], v[32:35], 0
    ds_read_b64_tr_b16 v[220:221], v15 offset:64
    v_exp_f32 v116, v116
    v_exp_f32 v117, v117
    v_exp_f32 v118, v118
    v_exp_f32 v119, v119
    v_mfma_f32_32x32x8_bf16 v[84:99], a[186:187], v[36:37], v[84:99]
    v_exp_f32 v120, v120
    v_exp_f32 v121, v121
    v_exp_f32 v122, v122
    v_exp_f32 v123, v123
    v_smfmac_f32_32x32x32_bf16 a[224:239], a[164:167], v[100:107], v2
    global_load_dwordx2 a[172:173], v4, s[28:29] offset:-1536 sc1
    v_exp_f32 v124, v124
    v_exp_f32 v125, v125
    v_exp_f32 v126, v126
    v_exp_f32 v127, v127
    v_smfmac_f32_32x32x32_bf16 a[224:239], a[168:171], v[108:115], v2
    ds_read_b64_tr_b16 v[222:223], v15 offset:1344
    v_exp_f32 v128, v128
    v_exp_f32 v129, v129
    v_exp_f32 v130, v130
    v_exp_f32 v131, v131
    v_mfma_f32_32x32x16_bf16 v[100:115], a[174:177], v[38:41], 0
    ds_read_b64_tr_b16 v[224:225], v15 offset:96
    v_exp_f32 v84, v84
    v_exp_f32 v85, v85
    v_exp_f32 v86, v86
    v_exp_f32 v87, v87
    v_mfma_f32_32x32x8_bf16 v[100:115], a[186:187], v[42:43], v[100:115]
    v_exp_f32 v88, v88
    v_exp_f32 v89, v89
    v_exp_f32 v90, v90
    v_exp_f32 v91, v91
    v_smfmac_f32_32x32x32_bf16 a[240:255], a[164:167], v[116:123], v2
    ds_read_b64_tr_b16 v[226:227], v15 offset:1376
    v_exp_f32 v92, v92
    v_exp_f32 v93, v93
    v_exp_f32 v94, v94
    v_exp_f32 v95, v95
    v_smfmac_f32_32x32x32_bf16 a[240:255], a[168:171], v[124:131], v2
    global_load_dwordx4 a[164:167], v3, s[28:29] offset:-3072 sc1
    v_exp_f32 v96, v96
    v_exp_f32 v97, v97
    v_exp_f32 v98, v98
    v_exp_f32 v99, v99
    v_mfma_f32_32x32x16_bf16 v[116:131], a[174:177], v[44:47], 0
    ds_read_b64_tr_b16 v[228:229], v15 offset:128
    v_exp_f32 v100, v100
    v_exp_f32 v101, v101
    v_exp_f32 v102, v102
    v_exp_f32 v103, v103
    v_mfma_f32_32x32x8_bf16 v[116:131], a[186:187], v[48:49], v[116:131]
    v_exp_f32 v104, v104
    v_exp_f32 v105, v105
    v_exp_f32 v106, v106
    v_exp_f32 v107, v107
    v_smfmac_f32_32x32x32_bf16 a[192:207], a[178:181], v[84:91], v2
    s_waitcnt vmcnt(7)
    global_load_dwordx4 a[168:171], v3, s[28:29] offset:-2304 sc1
    v_exp_f32 v108, v108
    v_exp_f32 v109, v109
    v_exp_f32 v110, v110
    v_exp_f32_e64 v111, v111
    v_smfmac_f32_32x32x32_bf16 a[192:207], a[182:185], v[92:99], v2
    ds_read_b64_tr_b16 v[230:231], v15 offset:1408
    v_exp_f32 v112, v112
    v_exp_f32 v113, v113
    v_exp_f32 v114, v114
    v_exp_f32 v115, v115
    v_mfma_f32_32x32x16_bf16 v[84:99], a[174:177], v[50:53], 0
    s_waitcnt lgkmcnt(0)
    v_exp_f32 v116, v116
    v_exp_f32 v117, v117
    v_exp_f32 v118, v118
    v_exp_f32_e64 v119, v119
    v_mfma_f32_32x32x8_bf16 v[84:99], a[186:187], v[54:55], v[84:99]
    v_exp_f32 v120, v120
    v_exp_f32 v121, v121
    v_exp_f32 v122, v122
    v_exp_f32 v123, v123
    v_smfmac_f32_32x32x32_bf16 a[208:223], a[178:181], v[100:107], v2
    global_load_dwordx4 a[174:177], v1, s[28:29] offset:0 sc1
    v_exp_f32 v124, v124
    v_exp_f32 v125, v125
    v_exp_f32 v126, v126
    v_exp_f32 v127, v127
    v_smfmac_f32_32x32x32_bf16 a[208:223], a[182:185], v[108:115], v2
    buffer_store_dwordx4 v[212:215], v10, s[40:43], s79 offen offset:0 sc1
    v_exp_f32 v128, v128
    v_exp_f32 v129, v129
    v_exp_f32 v130, v130
    v_exp_f32 v131, v131
    v_mfma_f32_32x32x16_bf16 v[100:115], v[56:59], v[32:35], 0
    buffer_store_dwordx4 v[216:219], v10, s[40:43], s79 offen offset:1024 sc1
    v_exp_f32 v84, v84
    v_exp_f32 v85, v85
    v_exp_f32 v86, v86
    v_exp_f32 v87, v87
    v_mfma_f32_32x32x8_bf16 v[100:115], v[68:69], v[36:37], v[100:115]
    v_exp_f32 v88, v88
    v_exp_f32 v89, v89
    v_exp_f32 v90, v90
    v_exp_f32 v91, v91
    v_smfmac_f32_32x32x32_bf16 a[224:239], a[178:181], v[116:123], v2
    global_load_dwordx2 a[186:187], v4, s[28:29] offset:2560 sc1
    v_exp_f32 v92, v92
    v_exp_f32 v93, v93
    v_exp_f32 v94, v94
    v_exp_f32 v95, v95
    v_smfmac_f32_32x32x32_bf16 a[224:239], a[182:185], v[124:131], v2
    buffer_store_dword v14, v13, s[40:43], 0 offen sc1
    v_exp_f32 v96, v96
    v_exp_f32 v97, v97
    v_exp_f32 v98, v98
    v_exp_f32 v99, v99
    v_mfma_f32_32x32x16_bf16 v[116:131], v[56:59], v[38:41], 0
    buffer_store_dwordx4 v[220:223], v10, s[40:43], s79 offen offset:2048 sc1
    v_exp_f32 v100, v100
    v_exp_f32 v101, v101
    v_exp_f32 v102, v102
    v_exp_f32 v103, v103
    v_mfma_f32_32x32x8_bf16 v[116:131], v[68:69], v[42:43], v[116:131]
    v_exp_f32 v104, v104
    v_exp_f32 v105, v105
    v_exp_f32 v106, v106
    v_exp_f32 v107, v107
    v_smfmac_f32_32x32x32_bf16 a[240:255], a[178:181], v[84:91], v2
    buffer_store_dwordx4 v[224:227], v10, s[40:43], s79 offen offset:3072 sc1
    v_exp_f32 v108, v108
    v_exp_f32 v109, v109
    v_exp_f32 v110, v110
    v_exp_f32 v111, v111
    v_smfmac_f32_32x32x32_bf16 a[240:255], a[182:185], v[92:99], v2
    s_add_u32 s79, s79, 1024
    global_load_dwordx4 a[178:181], v3, s[28:29] offset:1024 sc1
    v_exp_f32 v112, v112
    v_exp_f32 v113, v113
    v_exp_f32 v114, v114
    v_exp_f32 v115, v115
    v_mfma_f32_32x32x16_bf16 v[84:99], v[56:59], v[44:47], 0
    buffer_store_dwordx4 v[228:231], v10, s[40:43], s79 offen offset:3072 sc1
    v_exp_f32 v116, v116
    v_exp_f32 v117, v117
    v_exp_f32 v118, v118
    v_exp_f32 v119, v119
    v_mfma_f32_32x32x8_bf16 v[84:99], v[68:69], v[48:49], v[84:99]
    v_exp_f32 v120, v120
    v_exp_f32 v121, v121
    v_exp_f32 v122, v122
    v_exp_f32 v123, v123
    v_smfmac_f32_32x32x32_bf16 a[192:207], v[60:63], v[100:107], v2
    s_waitcnt vmcnt(13)
    global_load_dwordx4 a[182:185], v3, s[28:29] offset:1792 sc1
    v_exp_f32 v124, v124
    v_exp_f32 v125, v125
    v_exp_f32 v126, v126
    v_exp_f32_e64 v127, v127
    v_smfmac_f32_32x32x32_bf16 a[192:207], v[64:67], v[108:115], v2
    s_add_u32 s28, s28, 8192
    s_addc_u32 s29, s29, 0
    v_exp_f32 v128, v128
    v_exp_f32 v129, v129
    v_exp_f32 v130, v130
    v_exp_f32_e64 v131, v131
    v_mfma_f32_32x32x16_bf16 v[100:115], v[56:59], v[50:53], 0
    v_add_u32 v15, s74, v1
    s_barrier
    v_exp_f32 v84, v84
    v_exp_f32 v85, v85
    v_exp_f32 v86, v86
    v_exp_f32 v87, v87
    v_mfma_f32_32x32x8_bf16 v[100:115], v[68:69], v[54:55], v[100:115]
    v_exp_f32 v88, v88
    v_exp_f32 v89, v89
    v_exp_f32 v90, v90
    v_exp_f32 v91, v91
    v_smfmac_f32_32x32x32_bf16 a[208:223], v[60:63], v[116:123], v2
    global_load_dwordx4 v[56:59], v1, s[28:29] offset:-4096 sc1
    v_exp_f32 v92, v92
    v_exp_f32 v93, v93
    v_exp_f32 v94, v94
    v_exp_f32 v95, v95
    v_smfmac_f32_32x32x32_bf16 a[208:223], v[64:67], v[124:131], v2
    v_exp_f32 v96, v96
    v_exp_f32 v97, v97
    v_exp_f32 v98, v98
    v_exp_f32 v99, v99
    v_mfma_f32_32x32x16_bf16 v[116:131], v[70:73], v[32:35], 0
    v_exp_f32 v100, v100
    v_exp_f32 v101, v101
    v_exp_f32 v102, v102
    v_exp_f32 v103, v103
    v_mfma_f32_32x32x8_bf16 v[116:131], v[82:83], v[36:37], v[116:131]
    v_exp_f32 v104, v104
    v_exp_f32 v105, v105
    v_exp_f32 v106, v106
    v_exp_f32 v107, v107
    v_smfmac_f32_32x32x32_bf16 a[224:239], v[60:63], v[84:91], v2
    global_load_dwordx2 v[68:69], v4, s[28:29] offset:-1536 sc1
    v_exp_f32 v108, v108
    v_exp_f32 v109, v109
    v_exp_f32 v110, v110
    v_exp_f32 v111, v111
    v_smfmac_f32_32x32x32_bf16 a[224:239], v[64:67], v[92:99], v2
    v_exp_f32 v112, v112
    v_exp_f32 v113, v113
    v_exp_f32 v114, v114
    v_exp_f32 v115, v115
    v_mfma_f32_32x32x16_bf16 v[84:99], v[70:73], v[38:41], 0
    v_exp_f32 v116, v116
    v_exp_f32 v117, v117
    v_exp_f32 v118, v118
    v_exp_f32 v119, v119
    v_mfma_f32_32x32x8_bf16 v[84:99], v[82:83], v[42:43], v[84:99]
    v_exp_f32 v120, v120
    v_exp_f32 v121, v121
    v_exp_f32 v122, v122
    v_exp_f32 v123, v123
    v_smfmac_f32_32x32x32_bf16 a[240:255], v[60:63], v[100:107], v2
    v_exp_f32 v124, v124
    v_exp_f32 v125, v125
    v_exp_f32 v126, v126
    v_exp_f32 v127, v127
    v_smfmac_f32_32x32x32_bf16 a[240:255], v[64:67], v[108:115], v2
    global_load_dwordx4 v[60:63], v3, s[28:29] offset:-3072 sc1
    v_exp_f32 v128, v128
    v_exp_f32 v129, v129
    v_exp_f32 v130, v130
    v_exp_f32 v131, v131
    v_mfma_f32_32x32x16_bf16 v[100:115], v[70:73], v[44:47], 0
    v_exp_f32 v84, v84
    v_exp_f32 v85, v85
    v_exp_f32 v86, v86
    v_exp_f32 v87, v87
    v_mfma_f32_32x32x8_bf16 v[100:115], v[82:83], v[48:49], v[100:115]
    v_exp_f32 v88, v88
    v_exp_f32 v89, v89
    v_exp_f32 v90, v90
    v_exp_f32 v91, v91
    v_smfmac_f32_32x32x32_bf16 a[192:207], v[74:77], v[116:123], v2
    s_waitcnt vmcnt(13)
    global_load_dwordx4 v[64:67], v3, s[28:29] offset:-2304 sc1
    v_exp_f32 v92, v92
    v_exp_f32 v93, v93
    v_exp_f32 v94, v94
    v_exp_f32_e64 v95, v95
    v_smfmac_f32_32x32x32_bf16 a[192:207], v[78:81], v[124:131], v2
    v_exp_f32 v96, v96
    v_exp_f32 v97, v97
    v_exp_f32 v98, v98
    v_exp_f32 v99, v99
    v_mfma_f32_32x32x16_bf16 v[116:131], v[70:73], v[50:53], 0
    v_exp_f32 v100, v100
    v_exp_f32 v101, v101
    v_exp_f32 v102, v102
    v_exp_f32 v103, v103
    v_mfma_f32_32x32x8_bf16 v[116:131], v[82:83], v[54:55], v[116:131]
    v_exp_f32 v104, v104
    v_exp_f32 v105, v105
    v_exp_f32 v106, v106
    v_exp_f32 v107, v107
    v_smfmac_f32_32x32x32_bf16 a[208:223], v[74:77], v[84:91], v2
    global_load_dwordx4 v[70:73], v1, s[28:29] offset:0 sc1
    v_exp_f32 v108, v108
    v_exp_f32 v109, v109
    v_exp_f32 v110, v110
    v_exp_f32 v111, v111
    v_smfmac_f32_32x32x32_bf16 a[208:223], v[78:81], v[92:99], v2
    v_exp_f32 v112, v112
    v_exp_f32 v113, v113
    v_exp_f32 v114, v114
    v_exp_f32 v115, v115
    v_mfma_f32_32x32x16_bf16 v[84:99], a[160:163], v[32:35], 0
    v_exp_f32 v116, v116
    v_exp_f32 v117, v117
    v_exp_f32 v118, v118
    v_exp_f32 v119, v119
    v_mfma_f32_32x32x8_bf16 v[84:99], a[172:173], v[36:37], v[84:99]
    v_exp_f32 v120, v120
    v_exp_f32 v121, v121
    v_exp_f32 v122, v122
    v_exp_f32 v123, v123
    v_smfmac_f32_32x32x32_bf16 a[224:239], v[74:77], v[100:107], v2
    global_load_dwordx2 v[82:83], v4, s[28:29] offset:2560 sc1
    v_exp_f32 v124, v124
    v_exp_f32 v125, v125
    v_exp_f32 v126, v126
    v_exp_f32 v127, v127
    v_smfmac_f32_32x32x32_bf16 a[224:239], v[78:81], v[108:115], v2
    v_exp_f32 v128, v128
    v_exp_f32 v129, v129
    v_exp_f32 v130, v130
    v_exp_f32 v131, v131
    v_mfma_f32_32x32x16_bf16 v[100:115], a[160:163], v[38:41], 0
    v_exp_f32 v84, v84
    v_exp_f32 v85, v85
    v_exp_f32 v86, v86
    v_exp_f32 v87, v87
    v_mfma_f32_32x32x8_bf16 v[100:115], a[172:173], v[42:43], v[100:115]
    v_exp_f32 v88, v88
    v_exp_f32 v89, v89
    v_exp_f32 v90, v90
    v_exp_f32 v91, v91
    v_smfmac_f32_32x32x32_bf16 a[240:255], v[74:77], v[116:123], v2
    v_exp_f32 v92, v92
    v_exp_f32 v93, v93
    v_exp_f32 v94, v94
    v_exp_f32 v95, v95
    v_smfmac_f32_32x32x32_bf16 a[240:255], v[78:81], v[124:131], v2
    global_load_dwordx4 v[74:77], v3, s[28:29] offset:1024 sc1
    v_exp_f32 v96, v96
    v_exp_f32 v97, v97
    v_exp_f32 v98, v98
    v_exp_f32 v99, v99
    v_mfma_f32_32x32x16_bf16 v[116:131], a[160:163], v[44:47], 0
    v_exp_f32 v100, v100
    v_exp_f32 v101, v101
    v_exp_f32 v102, v102
    v_exp_f32 v103, v103
    v_mfma_f32_32x32x8_bf16 v[116:131], a[172:173], v[48:49], v[116:131]
    v_exp_f32 v104, v104
    v_exp_f32 v105, v105
    v_exp_f32 v106, v106
    v_exp_f32 v107, v107
    v_smfmac_f32_32x32x32_bf16 a[192:207], a[164:167], v[84:91], v2
    s_waitcnt vmcnt(7)
    global_load_dwordx4 v[78:81], v3, s[28:29] offset:1792 sc1
    v_exp_f32 v108, v108
    v_exp_f32 v109, v109
    v_exp_f32 v110, v110
    v_exp_f32_e64 v111, v111
    v_smfmac_f32_32x32x32_bf16 a[192:207], a[168:171], v[92:99], v2
    s_add_u32 s28, s28, 8192
    s_addc_u32 s29, s29, 0
    buffer_store_dword v14, v11, s[40:43], 0 offen sc1
    v_exp_f32 v112, v112
    v_exp_f32 v113, v113
    v_exp_f32 v114, v114
    v_exp_f32_e64 v115, v115
    v_mfma_f32_32x32x16_bf16 v[84:99], a[160:163], v[50:53], 0
    v_exp_f32 v116, v116
    v_exp_f32 v117, v117
    v_exp_f32 v118, v118
    v_exp_f32 v119, v119
    v_mfma_f32_32x32x8_bf16 v[84:99], a[172:173], v[54:55], v[84:99]
    v_exp_f32 v120, v120
    v_exp_f32 v121, v121
    v_exp_f32 v122, v122
    v_exp_f32 v123, v123
    v_smfmac_f32_32x32x32_bf16 a[208:223], a[164:167], v[100:107], v2
    global_load_dwordx4 a[160:163], v1, s[28:29] offset:-4096 sc1
    v_exp_f32 v124, v124
    v_exp_f32 v125, v125
    v_exp_f32 v126, v126
    v_exp_f32 v127, v127
    v_smfmac_f32_32x32x32_bf16 a[208:223], a[168:171], v[108:115], v2
    v_exp_f32 v128, v128
    v_exp_f32 v129, v129
    v_exp_f32 v130, v130
    v_exp_f32 v131, v131
    v_mfma_f32_32x32x16_bf16 v[100:115], a[174:177], v[32:35], 0
    v_exp_f32 v84, v84
    v_exp_f32 v85, v85
    v_exp_f32 v86, v86
    v_exp_f32 v87, v87
    v_mfma_f32_32x32x8_bf16 v[100:115], a[186:187], v[36:37], v[100:115]
    v_exp_f32 v88, v88
    v_exp_f32 v89, v89
    v_exp_f32 v90, v90
    v_exp_f32 v91, v91
    v_smfmac_f32_32x32x32_bf16 a[224:239], a[164:167], v[116:123], v2
    global_load_dwordx2 a[172:173], v4, s[28:29] offset:-1536 sc1
    v_exp_f32 v92, v92
    v_exp_f32 v93, v93
    v_exp_f32 v94, v94
    v_exp_f32 v95, v95
    v_smfmac_f32_32x32x32_bf16 a[224:239], a[168:171], v[124:131], v2
    v_exp_f32 v96, v96
    v_exp_f32 v97, v97
    v_exp_f32 v98, v98
    v_exp_f32 v99, v99
    v_mfma_f32_32x32x16_bf16 v[116:131], a[174:177], v[38:41], 0
    v_exp_f32 v100, v100
    v_exp_f32 v101, v101
    v_exp_f32 v102, v102
    v_exp_f32 v103, v103
    v_mfma_f32_32x32x8_bf16 v[116:131], a[186:187], v[42:43], v[116:131]
    v_exp_f32 v104, v104
    v_exp_f32 v105, v105
    v_exp_f32 v106, v106
    v_exp_f32 v107, v107
    v_smfmac_f32_32x32x32_bf16 a[240:255], a[164:167], v[84:91], v2
    v_exp_f32 v108, v108
    v_exp_f32 v109, v109
    v_exp_f32 v110, v110
    v_exp_f32 v111, v111
    v_smfmac_f32_32x32x32_bf16 a[240:255], a[168:171], v[92:99], v2
    global_load_dwordx4 a[164:167], v3, s[28:29] offset:-3072 sc1
    v_exp_f32 v112, v112
    v_exp_f32 v113, v113
    v_exp_f32 v114, v114
    v_exp_f32 v115, v115
    v_mfma_f32_32x32x16_bf16 v[84:99], a[174:177], v[44:47], 0
    v_exp_f32 v116, v116
    v_exp_f32 v117, v117
    v_exp_f32 v118, v118
    v_exp_f32 v119, v119
    v_mfma_f32_32x32x8_bf16 v[84:99], a[186:187], v[48:49], v[84:99]
    v_exp_f32 v120, v120
    v_exp_f32 v121, v121
    v_exp_f32 v122, v122
    v_exp_f32 v123, v123
    v_smfmac_f32_32x32x32_bf16 a[192:207], a[178:181], v[100:107], v2
    s_waitcnt vmcnt(8)
    global_load_dwordx4 a[168:171], v3, s[28:29] offset:-2304 sc1
    v_exp_f32 v124, v124
    v_exp_f32 v125, v125
    v_exp_f32 v126, v126
    v_exp_f32_e64 v127, v127
    v_smfmac_f32_32x32x32_bf16 a[192:207], a[182:185], v[108:115], v2
    v_exp_f32 v128, v128
    v_exp_f32 v129, v129
    v_exp_f32 v130, v130
    v_exp_f32 v131, v131
    v_mfma_f32_32x32x16_bf16 v[100:115], a[174:177], v[50:53], 0
    v_exp_f32 v84, v84
    v_exp_f32 v85, v85
    v_exp_f32 v86, v86
    v_exp_f32 v87, v87
    v_mfma_f32_32x32x8_bf16 v[100:115], a[186:187], v[54:55], v[100:115]
    v_exp_f32 v88, v88
    v_exp_f32 v89, v89
    v_exp_f32 v90, v90
    v_exp_f32 v91, v91
    v_smfmac_f32_32x32x32_bf16 a[208:223], a[178:181], v[116:123], v2
    global_load_dwordx4 a[174:177], v1, s[28:29] offset:0 sc1
    v_exp_f32 v92, v92
    v_exp_f32 v93, v93
    v_exp_f32 v94, v94
    v_exp_f32 v95, v95
    v_smfmac_f32_32x32x32_bf16 a[208:223], a[182:185], v[124:131], v2
    v_exp_f32 v96, v96
    v_exp_f32 v97, v97
    v_exp_f32 v98, v98
    v_exp_f32 v99, v99
    v_mfma_f32_32x32x16_bf16 v[116:131], v[56:59], v[32:35], 0
    v_exp_f32 v100, v100
    v_exp_f32 v101, v101
    v_exp_f32 v102, v102
    v_exp_f32 v103, v103
    v_mfma_f32_32x32x8_bf16 v[116:131], v[68:69], v[36:37], v[116:131]
    v_exp_f32 v104, v104
    v_exp_f32 v105, v105
    v_exp_f32 v106, v106
    v_exp_f32 v107, v107
    v_smfmac_f32_32x32x32_bf16 a[224:239], a[178:181], v[84:91], v2
    global_load_dwordx2 a[186:187], v4, s[28:29] offset:2560 sc1
    v_exp_f32 v108, v108
    v_exp_f32 v109, v109
    v_exp_f32 v110, v110
    v_exp_f32 v111, v111
    v_smfmac_f32_32x32x32_bf16 a[224:239], a[182:185], v[92:99], v2
    v_exp_f32 v112, v112
    v_exp_f32 v113, v113
    v_exp_f32 v114, v114
    v_exp_f32 v115, v115
    v_mfma_f32_32x32x16_bf16 v[84:99], v[56:59], v[38:41], 0
    v_exp_f32 v116, v116
    v_exp_f32 v117, v117
    v_exp_f32 v118, v118
    v_exp_f32 v119, v119
    v_mfma_f32_32x32x8_bf16 v[84:99], v[68:69], v[42:43], v[84:99]
    v_exp_f32 v120, v120
    v_exp_f32 v121, v121
    v_exp_f32 v122, v122
    v_exp_f32 v123, v123
    v_smfmac_f32_32x32x32_bf16 a[240:255], a[178:181], v[100:107], v2
    v_exp_f32 v124, v124
    v_exp_f32 v125, v125
    v_exp_f32 v126, v126
    v_exp_f32 v127, v127
    v_smfmac_f32_32x32x32_bf16 a[240:255], a[182:185], v[108:115], v2
    global_load_dwordx4 a[178:181], v3, s[28:29] offset:1024 sc1
    v_exp_f32 v128, v128
    v_exp_f32 v129, v129
    v_exp_f32 v130, v130
    v_exp_f32 v131, v131
    v_mfma_f32_32x32x16_bf16 v[100:115], v[56:59], v[44:47], 0
    v_exp_f32 v84, v84
    v_exp_f32 v85, v85
    v_exp_f32 v86, v86
    v_exp_f32 v87, v87
    v_mfma_f32_32x32x8_bf16 v[100:115], v[68:69], v[48:49], v[100:115]
    v_exp_f32 v88, v88
    v_exp_f32 v89, v89
    v_exp_f32 v90, v90
    v_exp_f32 v91, v91
    v_smfmac_f32_32x32x32_bf16 a[192:207], v[60:63], v[116:123], v2
    s_waitcnt vmcnt(8)
    global_load_dwordx4 a[182:185], v3, s[28:29] offset:1792 sc1
    v_exp_f32 v92, v92
    v_exp_f32 v93, v93
    v_exp_f32 v94, v94
    v_exp_f32_e64 v95, v95
    v_smfmac_f32_32x32x32_bf16 a[192:207], v[64:67], v[124:131], v2
    s_add_u32 s28, s28, 8192
    s_addc_u32 s29, s29, 0
    v_exp_f32 v96, v96
    v_exp_f32 v97, v97
    v_exp_f32 v98, v98
    v_exp_f32_e64 v99, v99
    v_mfma_f32_32x32x16_bf16 v[116:131], v[56:59], v[50:53], 0
    v_exp_f32 v100, v100
    v_exp_f32 v101, v101
    v_exp_f32 v102, v102
    v_exp_f32 v103, v103
    v_mfma_f32_32x32x8_bf16 v[116:131], v[68:69], v[54:55], v[116:131]
    v_exp_f32 v104, v104
    v_exp_f32 v105, v105
    v_exp_f32 v106, v106
    v_exp_f32 v107, v107
    v_smfmac_f32_32x32x32_bf16 a[208:223], v[60:63], v[84:91], v2
    global_load_dwordx4 v[56:59], v1, s[28:29] offset:-4096 sc1
    v_exp_f32 v108, v108
    v_exp_f32 v109, v109
    v_exp_f32 v110, v110
    v_exp_f32 v111, v111
    v_smfmac_f32_32x32x32_bf16 a[208:223], v[64:67], v[92:99], v2
    v_exp_f32 v112, v112
    v_exp_f32 v113, v113
    v_exp_f32 v114, v114
    v_exp_f32 v115, v115
    v_mfma_f32_32x32x16_bf16 v[84:99], v[70:73], v[32:35], 0
    v_exp_f32 v116, v116
    v_exp_f32 v117, v117
    v_exp_f32 v118, v118
    v_exp_f32 v119, v119
    v_mfma_f32_32x32x8_bf16 v[84:99], v[82:83], v[36:37], v[84:99]
    v_exp_f32 v120, v120
    v_exp_f32 v121, v121
    v_exp_f32 v122, v122
    v_exp_f32 v123, v123
    v_smfmac_f32_32x32x32_bf16 a[224:239], v[60:63], v[100:107], v2
    global_load_dwordx2 v[68:69], v4, s[28:29] offset:-1536 sc1
    v_exp_f32 v124, v124
    v_exp_f32 v125, v125
    v_exp_f32 v126, v126
    v_exp_f32 v127, v127
    v_smfmac_f32_32x32x32_bf16 a[224:239], v[64:67], v[108:115], v2
    v_exp_f32 v128, v128
    v_exp_f32 v129, v129
    v_exp_f32 v130, v130
    v_exp_f32 v131, v131
    v_mfma_f32_32x32x16_bf16 v[100:115], v[70:73], v[38:41], 0
    v_exp_f32 v84, v84
    v_exp_f32 v85, v85
    v_exp_f32 v86, v86
    v_exp_f32 v87, v87
    v_mfma_f32_32x32x8_bf16 v[100:115], v[82:83], v[42:43], v[100:115]
    v_exp_f32 v88, v88
    v_exp_f32 v89, v89
    v_exp_f32 v90, v90
    v_exp_f32 v91, v91
    v_smfmac_f32_32x32x32_bf16 a[240:255], v[60:63], v[116:123], v2
    v_exp_f32 v92, v92
    v_exp_f32 v93, v93
    v_exp_f32 v94, v94
    v_exp_f32 v95, v95
    v_smfmac_f32_32x32x32_bf16 a[240:255], v[64:67], v[124:131], v2
    global_load_dwordx4 v[60:63], v3, s[28:29] offset:-3072 sc1
    v_exp_f32 v96, v96
    v_exp_f32 v97, v97
    v_exp_f32 v98, v98
    v_exp_f32 v99, v99
    v_mfma_f32_32x32x16_bf16 v[116:131], v[70:73], v[44:47], 0
    v_exp_f32 v100, v100
    v_exp_f32 v101, v101
    v_exp_f32 v102, v102
    v_exp_f32 v103, v103
    v_mfma_f32_32x32x8_bf16 v[116:131], v[82:83], v[48:49], v[116:131]
    v_exp_f32 v104, v104
    v_exp_f32 v105, v105
    v_exp_f32 v106, v106
    v_exp_f32 v107, v107
    v_smfmac_f32_32x32x32_bf16 a[192:207], v[74:77], v[84:91], v2
    s_waitcnt vmcnt(7)
    global_load_dwordx4 v[64:67], v3, s[28:29] offset:-2304 sc1
    v_exp_f32 v108, v108
    v_exp_f32 v109, v109
    v_exp_f32 v110, v110
    v_exp_f32_e64 v111, v111
    v_smfmac_f32_32x32x32_bf16 a[192:207], v[78:81], v[92:99], v2
    buffer_load_dword v26, v12, s[40:43], 0 offen sc1
    v_exp_f32 v112, v112
    v_exp_f32 v113, v113
    v_exp_f32 v114, v114
    v_exp_f32 v115, v115
    v_mfma_f32_32x32x16_bf16 v[84:99], v[70:73], v[50:53], 0
    v_exp_f32 v116, v116
    v_exp_f32 v117, v117
    v_exp_f32 v118, v118
    v_exp_f32 v119, v119
    v_mfma_f32_32x32x8_bf16 v[84:99], v[82:83], v[54:55], v[84:99]
    v_exp_f32 v120, v120
    v_exp_f32 v121, v121
    v_exp_f32 v122, v122
    v_exp_f32 v123, v123
    v_smfmac_f32_32x32x32_bf16 a[208:223], v[74:77], v[100:107], v2
    global_load_dwordx4 v[70:73], v1, s[28:29] offset:0 sc1
    v_exp_f32 v124, v124
    v_exp_f32 v125, v125
    v_exp_f32 v126, v126
    v_exp_f32 v127, v127
    v_smfmac_f32_32x32x32_bf16 a[208:223], v[78:81], v[108:115], v2
    v_exp_f32 v128, v128
    v_exp_f32 v129, v129
    v_exp_f32 v130, v130
    v_exp_f32 v131, v131
    v_mfma_f32_32x32x16_bf16 v[100:115], a[160:163], v[32:35], 0
    v_exp_f32 v84, v84
    v_exp_f32 v85, v85
    v_exp_f32 v86, v86
    v_exp_f32 v87, v87
    v_mfma_f32_32x32x8_bf16 v[100:115], a[172:173], v[36:37], v[100:115]
    v_exp_f32 v88, v88
    v_exp_f32 v89, v89
    v_exp_f32 v90, v90
    v_exp_f32 v91, v91
    v_smfmac_f32_32x32x32_bf16 a[224:239], v[74:77], v[116:123], v2
    global_load_dwordx2 v[82:83], v4, s[28:29] offset:2560 sc1
    v_exp_f32 v92, v92
    v_exp_f32 v93, v93
    v_exp_f32 v94, v94
    v_exp_f32 v95, v95
    v_smfmac_f32_32x32x32_bf16 a[224:239], v[78:81], v[124:131], v2
    v_exp_f32 v96, v96
    v_exp_f32 v97, v97
    v_exp_f32 v98, v98
    v_exp_f32 v99, v99
    v_mfma_f32_32x32x16_bf16 v[116:131], a[160:163], v[38:41], 0
    v_exp_f32 v100, v100
    v_exp_f32 v101, v101
    v_exp_f32 v102, v102
    v_exp_f32 v103, v103
    v_mfma_f32_32x32x8_bf16 v[116:131], a[172:173], v[42:43], v[116:131]
    v_exp_f32 v104, v104
    v_exp_f32 v105, v105
    v_exp_f32 v106, v106
    v_exp_f32 v107, v107
    v_smfmac_f32_32x32x32_bf16 a[240:255], v[74:77], v[84:91], v2
    v_exp_f32 v108, v108
    v_exp_f32 v109, v109
    v_exp_f32 v110, v110
    v_exp_f32 v111, v111
    v_smfmac_f32_32x32x32_bf16 a[240:255], v[78:81], v[92:99], v2
    global_load_dwordx4 v[74:77], v3, s[28:29] offset:1024 sc1
    v_exp_f32 v112, v112
    v_exp_f32 v113, v113
    v_exp_f32 v114, v114
    v_exp_f32 v115, v115
    v_mfma_f32_32x32x16_bf16 v[84:99], a[160:163], v[44:47], 0
    v_exp_f32 v116, v116
    v_exp_f32 v117, v117
    v_exp_f32 v118, v118
    v_exp_f32 v119, v119
    v_mfma_f32_32x32x8_bf16 v[84:99], a[172:173], v[48:49], v[84:99]
    v_exp_f32 v120, v120
    v_exp_f32 v121, v121
    v_exp_f32 v122, v122
    v_exp_f32 v123, v123
    v_smfmac_f32_32x32x32_bf16 a[192:207], a[164:167], v[100:107], v2
    s_waitcnt vmcnt(8)
    global_load_dwordx4 v[78:81], v3, s[28:29] offset:1792 sc1
    v_exp_f32 v124, v124
    v_exp_f32 v125, v125
    v_exp_f32 v126, v126
    v_exp_f32_e64 v127, v127
    v_smfmac_f32_32x32x32_bf16 a[192:207], a[168:171], v[108:115], v2
    s_add_u32 s28, s28, 8192
    s_addc_u32 s29, s29, 0
    v_exp_f32 v128, v128
    v_exp_f32 v129, v129
    v_exp_f32 v130, v130
    v_exp_f32_e64 v131, v131
    v_mfma_f32_32x32x16_bf16 v[100:115], a[160:163], v[50:53], 0
    v_exp_f32 v84, v84
    v_exp_f32 v85, v85
    v_exp_f32 v86, v86
    v_exp_f32 v87, v87
    v_mfma_f32_32x32x8_bf16 v[100:115], a[172:173], v[54:55], v[100:115]
    v_exp_f32 v88, v88
    v_exp_f32 v89, v89
    v_exp_f32 v90, v90
    v_exp_f32 v91, v91
    v_smfmac_f32_32x32x32_bf16 a[208:223], a[164:167], v[116:123], v2
    global_load_dwordx4 a[160:163], v1, s[28:29] offset:-4096 sc1
    v_exp_f32 v92, v92
    v_exp_f32 v93, v93
    v_exp_f32 v94, v94
    v_exp_f32 v95, v95
    v_smfmac_f32_32x32x32_bf16 a[208:223], a[168:171], v[124:131], v2
    v_exp_f32 v96, v96
    v_exp_f32 v97, v97
    v_exp_f32 v98, v98
    v_exp_f32 v99, v99
    v_mfma_f32_32x32x16_bf16 v[116:131], a[174:177], v[32:35], 0
    v_exp_f32 v100, v100
    v_exp_f32 v101, v101
    v_exp_f32 v102, v102
    v_exp_f32 v103, v103
    v_mfma_f32_32x32x8_bf16 v[116:131], a[186:187], v[36:37], v[116:131]
    v_exp_f32 v104, v104
    v_exp_f32 v105, v105
    v_exp_f32 v106, v106
    v_exp_f32 v107, v107
    v_smfmac_f32_32x32x32_bf16 a[224:239], a[164:167], v[84:91], v2
    global_load_dwordx2 a[172:173], v4, s[28:29] offset:-1536 sc1
    v_exp_f32 v108, v108
    v_exp_f32 v109, v109
    v_exp_f32 v110, v110
    v_exp_f32 v111, v111
    v_smfmac_f32_32x32x32_bf16 a[224:239], a[168:171], v[92:99], v2
    v_exp_f32 v112, v112
    v_exp_f32 v113, v113
    v_exp_f32 v114, v114
    v_exp_f32 v115, v115
    v_mfma_f32_32x32x16_bf16 v[84:99], a[174:177], v[38:41], 0
    v_exp_f32 v116, v116
    v_exp_f32 v117, v117
    v_exp_f32 v118, v118
    v_exp_f32 v119, v119
    v_mfma_f32_32x32x8_bf16 v[84:99], a[186:187], v[42:43], v[84:99]
    v_exp_f32 v120, v120
    v_exp_f32 v121, v121
    v_exp_f32 v122, v122
    v_exp_f32 v123, v123
    v_smfmac_f32_32x32x32_bf16 a[240:255], a[164:167], v[100:107], v2
    v_exp_f32 v124, v124
    v_exp_f32 v125, v125
    v_exp_f32 v126, v126
    v_exp_f32 v127, v127
    v_smfmac_f32_32x32x32_bf16 a[240:255], a[168:171], v[108:115], v2
    global_load_dwordx4 a[164:167], v3, s[28:29] offset:-3072 sc1
    v_exp_f32 v128, v128
    v_exp_f32 v129, v129
    v_exp_f32 v130, v130
    v_exp_f32 v131, v131
    v_mfma_f32_32x32x16_bf16 v[100:115], a[174:177], v[44:47], 0
    v_exp_f32 v84, v84
    v_exp_f32 v85, v85
    v_exp_f32 v86, v86
    v_exp_f32 v87, v87
    v_mfma_f32_32x32x8_bf16 v[100:115], a[186:187], v[48:49], v[100:115]
    v_exp_f32 v88, v88
    v_exp_f32 v89, v89
    v_exp_f32 v90, v90
    v_exp_f32 v91, v91
    v_smfmac_f32_32x32x32_bf16 a[192:207], a[178:181], v[116:123], v2
    s_waitcnt vmcnt(8)
    global_load_dwordx4 a[168:171], v3, s[28:29] offset:-2304 sc1
    v_exp_f32 v92, v92
    v_exp_f32 v93, v93
    v_exp_f32 v94, v94
    v_exp_f32_e64 v95, v95
    v_smfmac_f32_32x32x32_bf16 a[192:207], a[182:185], v[124:131], v2
    s_waitcnt vmcnt(8)
    v_cmp_gt_u32 vcc, 1, v26
    s_nop 0
    s_cbranch_vccz L_f2_ok
    s_mov_b32 s78, 0x40000
L_f2_spin:
    buffer_load_dword v26, v12, s[40:43], 0 offen sc1
    s_waitcnt vmcnt(0)
    v_cmp_gt_u32 vcc, 1, v26
    s_nop 1
    s_cbranch_vccz L_f2_ok
    s_sub_u32 s78, s78, 1
    s_cmp_lg_u32 s78, 0
    s_cbranch_scc1 L_f2_spin
L_f2_ok:
    v_exp_f32 v96, v96
    v_exp_f32 v97, v97
    v_exp_f32 v98, v98
    v_exp_f32_e64 v99, v99
    v_mfma_f32_32x32x16_bf16 v[116:131], a[174:177], v[50:53], 0
    global_load_dwordx4 a[0:3], v22, s[30:31] offset:-4096 sc1
    v_exp_f32 v100, v100
    v_exp_f32 v101, v101
    v_exp_f32 v102, v102
    v_exp_f32 v103, v103
    v_mfma_f32_32x32x8_bf16 v[116:131], a[186:187], v[54:55], v[116:131]
    v_exp_f32 v104, v104
    v_exp_f32 v105, v105
    v_exp_f32 v106, v106
    v_exp_f32 v107, v107
    v_smfmac_f32_32x32x32_bf16 a[208:223], a[178:181], v[84:91], v2
    global_load_dwordx4 a[174:177], v1, s[28:29] offset:0 sc1
    v_exp_f32 v108, v108
    v_exp_f32 v109, v109
    v_exp_f32 v110, v110
    v_exp_f32 v111, v111
    v_smfmac_f32_32x32x32_bf16 a[208:223], a[182:185], v[92:99], v2
    s_add_u32 s52, s72, 5120
    s_addc_u32 s53, s73, 0
    v_exp_f32 v112, v112
    v_exp_f32 v113, v113
    v_exp_f32 v114, v114
    v_exp_f32_e64 v115, v115
    v_mfma_f32_32x32x16_bf16 v[84:99], v[56:59], v[32:35], 0
    s_add_u32 m0, s74, 0
    v_exp_f32 v116, v116
    v_exp_f32 v117, v117
    v_exp_f32 v118, v118
    v_exp_f32_e64 v119, v119
    v_mfma_f32_32x32x8_bf16 v[84:99], v[68:69], v[36:37], v[84:99]
    v_exp_f32 v120, v120
    v_exp_f32 v121, v121
    v_exp_f32 v122, v122
    v_exp_f32 v123, v123
    v_smfmac_f32_32x32x32_bf16 a[224:239], a[178:181], v[100:107], v2
    global_load_dwordx2 a[186:187], v4, s[28:29] offset:2560 sc1
    v_exp_f32 v124, v124
    v_exp_f32 v125, v125
    v_exp_f32 v126, v126
    v_exp_f32 v127, v127
    v_smfmac_f32_32x32x32_bf16 a[224:239], a[182:185], v[108:115], v2
    global_load_lds_dwordx4 v1, s[52:53] offset:0 sc1
    v_exp_f32 v128, v128
    v_exp_f32 v129, v129
    v_exp_f32 v130, v130
    v_exp_f32 v131, v131
    v_mfma_f32_32x32x16_bf16 v[100:115], v[56:59], v[38:41], 0
    global_load_lds_dwordx4 v1, s[52:53] offset:1024 sc1
    v_exp_f32 v84, v84
    v_exp_f32 v85, v85
    v_exp_f32 v86, v86
    v_exp_f32 v87, v87
    v_mfma_f32_32x32x8_bf16 v[100:115], v[68:69], v[42:43], v[100:115]
    v_exp_f32 v88, v88
    v_exp_f32 v89, v89
    v_exp_f32 v90, v90
    v_exp_f32 v91, v91
    v_smfmac_f32_32x32x32_bf16 a[240:255], a[178:181], v[116:123], v2
    global_load_dwordx4 a[4:7], v23, s[30:31] offset:-4096 sc1
    v_exp_f32 v92, v92
    v_exp_f32 v93, v93
    v_exp_f32 v94, v94
    v_exp_f32 v95, v95
    v_smfmac_f32_32x32x32_bf16 a[240:255], a[182:185], v[124:131], v2
    global_load_dwordx4 a[178:181], v3, s[28:29] offset:1024 sc1
    v_exp_f32 v96, v96
    v_exp_f32 v97, v97
    v_exp_f32 v98, v98
    v_exp_f32 v99, v99
    v_mfma_f32_32x32x16_bf16 v[116:131], v[56:59], v[44:47], 0
    global_load_lds_dwordx4 v1, s[52:53] offset:2048 sc1
    v_exp_f32 v100, v100
    v_exp_f32 v101, v101
    v_exp_f32 v102, v102
    v_exp_f32 v103, v103
    v_mfma_f32_32x32x8_bf16 v[116:131], v[68:69], v[48:49], v[116:131]
    v_exp_f32 v104, v104
    v_exp_f32 v105, v105
    v_exp_f32 v106, v106
    v_exp_f32 v107, v107
    v_smfmac_f32_32x32x32_bf16 a[192:207], v[60:63], v[84:91], v2
    s_waitcnt vmcnt(12)
    global_load_dwordx4 a[182:185], v3, s[28:29] offset:1792 sc1
    v_exp_f32 v108, v108
    v_exp_f32 v109, v109
    v_exp_f32 v110, v110
    v_exp_f32_e64 v111, v111
    v_smfmac_f32_32x32x32_bf16 a[192:207], v[64:67], v[92:99], v2
    s_add_u32 s28, s28, 8192
    s_addc_u32 s29, s29, 0
    v_exp_f32 v112, v112
    v_exp_f32 v113, v113
    v_exp_f32 v114, v114
    v_exp_f32_e64 v115, v115
    v_mfma_f32_32x32x16_bf16 v[84:99], v[56:59], v[50:53], 0
    global_load_lds_dwordx4 v1, s[52:53] offset:3072 sc1
    v_exp_f32 v116, v116
    v_exp_f32 v117, v117
    v_exp_f32 v118, v118
    v_exp_f32 v119, v119
    v_mfma_f32_32x32x8_bf16 v[84:99], v[68:69], v[54:55], v[84:99]
    v_exp_f32 v120, v120
    v_exp_f32 v121, v121
    v_exp_f32 v122, v122
    v_exp_f32 v123, v123
    v_smfmac_f32_32x32x32_bf16 a[208:223], v[60:63], v[100:107], v2
    global_load_dwordx4 v[56:59], v1, s[28:29] offset:-4096 sc1
    v_exp_f32 v124, v124
    v_exp_f32 v125, v125
    v_exp_f32 v126, v126
    v_exp_f32 v127, v127
    v_smfmac_f32_32x32x32_bf16 a[208:223], v[64:67], v[108:115], v2
    global_load_dwordx4 a[8:11], v24, s[30:31] offset:-4096 sc1
    v_exp_f32 v128, v128
    v_exp_f32 v129, v129
    v_exp_f32 v130, v130
    v_exp_f32 v131, v131
    v_mfma_f32_32x32x16_bf16 v[100:115], v[70:73], v[32:35], 0
    global_load_dwordx4 a[12:15], v25, s[30:31] offset:-4096 sc1
    v_exp_f32 v84, v84
    v_exp_f32 v85, v85
    v_exp_f32 v86, v86
    v_exp_f32 v87, v87
    v_mfma_f32_32x32x8_bf16 v[100:115], v[82:83], v[36:37], v[100:115]
    v_exp_f32 v88, v88
    v_exp_f32 v89, v89
    v_exp_f32 v90, v90
    v_exp_f32 v91, v91
    v_smfmac_f32_32x32x32_bf16 a[224:239], v[60:63], v[116:123], v2
    global_load_dwordx2 v[68:69], v4, s[28:29] offset:-1536 sc1
    v_exp_f32 v92, v92
    v_exp_f32 v93, v93
    v_exp_f32 v94, v94
    v_exp_f32 v95, v95
    v_smfmac_f32_32x32x32_bf16 a[224:239], v[64:67], v[124:131], v2
    s_add_u32 s52, s72, 9216
    s_addc_u32 s53, s73, 0
    v_exp_f32 v96, v96
    v_exp_f32 v97, v97
    v_exp_f32 v98, v98
    v_exp_f32_e64 v99, v99
    v_mfma_f32_32x32x16_bf16 v[116:131], v[70:73], v[38:41], 0
    s_add_u32 m0, s74, 4096
    v_exp_f32 v100, v100
    v_exp_f32 v101, v101
    v_exp_f32 v102, v102
    v_exp_f32 v103, v103
    v_mfma_f32_32x32x8_bf16 v[116:131], v[82:83], v[42:43], v[116:131]
    v_exp_f32 v104, v104
    v_exp_f32 v105, v105
    v_exp_f32 v106, v106
    v_exp_f32 v107, v107
    v_smfmac_f32_32x32x32_bf16 a[240:255], v[60:63], v[84:91], v2
    global_load_lds_dwordx4 v1, s[52:53] offset:0 sc1
    v_exp_f32 v108, v108
    v_exp_f32 v109, v109
    v_exp_f32 v110, v110
    v_exp_f32 v111, v111
    v_smfmac_f32_32x32x32_bf16 a[240:255], v[64:67], v[92:99], v2
    global_load_dwordx4 v[60:63], v3, s[28:29] offset:-3072 sc1
    v_exp_f32 v112, v112
    v_exp_f32 v113, v113
    v_exp_f32 v114, v114
    v_exp_f32 v115, v115
    v_mfma_f32_32x32x16_bf16 v[84:99], v[70:73], v[44:47], 0
    global_load_lds_dwordx4 v1, s[52:53] offset:1024 sc1
    v_exp_f32 v116, v116
    v_exp_f32 v117, v117
    v_exp_f32 v118, v118
    v_exp_f32 v119, v119
    v_mfma_f32_32x32x8_bf16 v[84:99], v[82:83], v[48:49], v[84:99]
    v_exp_f32 v120, v120
    v_exp_f32 v121, v121
    v_exp_f32 v122, v122
    v_exp_f32 v123, v123
    v_smfmac_f32_32x32x32_bf16 a[192:207], v[74:77], v[100:107], v2
    s_waitcnt vmcnt(17)
    global_load_dwordx4 v[64:67], v3, s[28:29] offset:-2304 sc1
    v_exp_f32 v124, v124
    v_exp_f32 v125, v125
    v_exp_f32 v126, v126
    v_exp_f32_e64 v127, v127
    v_smfmac_f32_32x32x32_bf16 a[192:207], v[78:81], v[108:115], v2
    global_load_lds_dwordx4 v1, s[52:53] offset:2048 sc1
    v_exp_f32 v128, v128
    v_exp_f32 v129, v129
    v_exp_f32 v130, v130
    v_exp_f32 v131, v131
    v_mfma_f32_32x32x16_bf16 v[100:115], v[70:73], v[50:53], 0
    global_load_dwordx4 a[16:19], v22, s[30:31] offset:0 sc1
    v_exp_f32 v84, v84
    v_exp_f32 v85, v85
    v_exp_f32 v86, v86
    v_exp_f32 v87, v87
    v_mfma_f32_32x32x8_bf16 v[100:115], v[82:83], v[54:55], v[100:115]
    v_exp_f32 v88, v88
    v_exp_f32 v89, v89
    v_exp_f32 v90, v90
    v_exp_f32 v91, v91
    v_smfmac_f32_32x32x32_bf16 a[208:223], v[74:77], v[116:123], v2
    global_load_dwordx4 v[70:73], v1, s[28:29] offset:0 sc1
    v_exp_f32 v92, v92
    v_exp_f32 v93, v93
    v_exp_f32 v94, v94
    v_exp_f32 v95, v95
    v_smfmac_f32_32x32x32_bf16 a[208:223], v[78:81], v[124:131], v2
    global_load_lds_dwordx4 v1, s[52:53] offset:3072 sc1
    v_exp_f32 v96, v96
    v_exp_f32 v97, v97
    v_exp_f32 v98, v98
    v_exp_f32 v99, v99
    v_mfma_f32_32x32x16_bf16 v[116:131], a[160:163], v[32:35], 0
    global_load_dwordx4 a[20:23], v23, s[30:31] offset:0 sc1
    v_exp_f32 v100, v100
    v_exp_f32 v101, v101
    v_exp_f32 v102, v102
    v_exp_f32 v103, v103
    v_mfma_f32_32x32x8_bf16 v[116:131], a[172:173], v[36:37], v[116:131]
    v_exp_f32 v104, v104
    v_exp_f32 v105, v105
    v_exp_f32 v106, v106
    v_exp_f32 v107, v107
    v_smfmac_f32_32x32x32_bf16 a[224:239], v[74:77], v[84:91], v2
    global_load_dwordx2 v[82:83], v4, s[28:29] offset:2560 sc1
    v_exp_f32 v108, v108
    v_exp_f32 v109, v109
    v_exp_f32 v110, v110
    v_exp_f32 v111, v111
    v_smfmac_f32_32x32x32_bf16 a[224:239], v[78:81], v[92:99], v2
    s_add_u32 s52, s72, 13312
    s_addc_u32 s53, s73, 0
    v_exp_f32 v112, v112
    v_exp_f32 v113, v113
    v_exp_f32 v114, v114
    v_exp_f32_e64 v115, v115
    v_mfma_f32_32x32x16_bf16 v[84:99], a[160:163], v[38:41], 0
    s_add_u32 m0, s74, 8192
    v_exp_f32 v116, v116
    v_exp_f32 v117, v117
    v_exp_f32 v118, v118
    v_exp_f32 v119, v119
    v_mfma_f32_32x32x8_bf16 v[84:99], a[172:173], v[42:43], v[84:99]
    v_exp_f32 v120, v120
    v_exp_f32 v121, v121
    v_exp_f32 v122, v122
    v_exp_f32 v123, v123
    v_smfmac_f32_32x32x32_bf16 a[240:255], v[74:77], v[100:107], v2
    global_load_lds_dwordx4 v1, s[52:53] offset:0 sc1
    v_exp_f32 v124, v124
    v_exp_f32 v125, v125
    v_exp_f32 v126, v126
    v_exp_f32 v127, v127
    v_smfmac_f32_32x32x32_bf16 a[240:255], v[78:81], v[108:115], v2
    global_load_dwordx4 v[74:77], v3, s[28:29] offset:1024 sc1
    v_exp_f32 v128, v128
    v_exp_f32 v129, v129
    v_exp_f32 v130, v130
    v_exp_f32 v131, v131
    v_mfma_f32_32x32x16_bf16 v[100:115], a[160:163], v[44:47], 0
    global_load_dwordx4 a[24:27], v24, s[30:31] offset:0 sc1
    v_exp_f32 v84, v84
    v_exp_f32 v85, v85
    v_exp_f32 v86, v86
    v_exp_f32 v87, v87
    v_mfma_f32_32x32x8_bf16 v[100:115], a[172:173], v[48:49], v[100:115]
    v_exp_f32 v88, v88
    v_exp_f32 v89, v89
    v_exp_f32 v90, v90
    v_exp_f32 v91, v91
    v_smfmac_f32_32x32x32_bf16 a[192:207], a[164:167], v[116:123], v2
    s_waitcnt vmcnt(18)
    global_load_dwordx4 v[78:81], v3, s[28:29] offset:1792 sc1
    v_exp_f32 v92, v92
    v_exp_f32 v93, v93
    v_exp_f32 v94, v94
    v_exp_f32_e64 v95, v95
    v_smfmac_f32_32x32x32_bf16 a[192:207], a[168:171], v[124:131], v2
    s_add_u32 s28, s28, 8192
    s_addc_u32 s29, s29, 0
    v_exp_f32 v96, v96
    v_exp_f32 v97, v97
    v_exp_f32 v98, v98
    v_exp_f32_e64 v99, v99
    v_mfma_f32_32x32x16_bf16 v[116:131], a[160:163], v[50:53], 0
    global_load_lds_dwordx4 v1, s[52:53] offset:1024 sc1
    v_exp_f32 v100, v100
    v_exp_f32 v101, v101
    v_exp_f32 v102, v102
    v_exp_f32 v103, v103
    v_mfma_f32_32x32x8_bf16 v[116:131], a[172:173], v[54:55], v[116:131]
    v_exp_f32 v104, v104
    v_exp_f32 v105, v105
    v_exp_f32 v106, v106
    v_exp_f32 v107, v107
    v_smfmac_f32_32x32x32_bf16 a[208:223], a[164:167], v[84:91], v2
    global_load_dwordx4 a[160:163], v1, s[28:29] offset:-4096 sc1
    v_exp_f32 v108, v108
    v_exp_f32 v109, v109
    v_exp_f32 v110, v110
    v_exp_f32 v111, v111
    v_smfmac_f32_32x32x32_bf16 a[208:223], a[168:171], v[92:99], v2
    global_load_lds_dwordx4 v1, s[52:53] offset:2048 sc1
    v_exp_f32 v112, v112
    v_exp_f32 v113, v113
    v_exp_f32 v114, v114
    v_exp_f32 v115, v115
    v_mfma_f32_32x32x16_bf16 v[84:99], a[174:177], v[32:35], 0
    global_load_dwordx4 a[28:31], v25, s[30:31] offset:0 sc1
    v_exp_f32 v116, v116
    v_exp_f32 v117, v117
    v_exp_f32 v118, v118
    v_exp_f32 v119, v119
    v_mfma_f32_32x32x8_bf16 v[84:99], a[186:187], v[36:37], v[84:99]
    v_exp_f32 v120, v120
    v_exp_f32 v121, v121
    v_exp_f32 v122, v122
    v_exp_f32 v123, v123
    v_smfmac_f32_32x32x32_bf16 a[224:239], a[164:167], v[100:107], v2
    global_load_dwordx2 a[172:173], v4, s[28:29] offset:-1536 sc1
    v_exp_f32 v124, v124
    v_exp_f32 v125, v125
    v_exp_f32 v126, v126
    v_exp_f32 v127, v127
    v_smfmac_f32_32x32x32_bf16 a[224:239], a[168:171], v[108:115], v2
    global_load_lds_dwordx4 v1, s[52:53] offset:3072 sc1
    v_exp_f32 v128, v128
    v_exp_f32 v129, v129
    v_exp_f32 v130, v130
    v_exp_f32 v131, v131
    v_mfma_f32_32x32x16_bf16 v[100:115], a[174:177], v[38:41], 0
    v_exp_f32 v84, v84
    v_exp_f32 v85, v85
    v_exp_f32 v86, v86
    v_exp_f32 v87, v87
    v_mfma_f32_32x32x8_bf16 v[100:115], a[186:187], v[42:43], v[100:115]
    v_exp_f32 v88, v88
    v_exp_f32 v89, v89
    v_exp_f32 v90, v90
    v_exp_f32 v91, v91
    v_smfmac_f32_32x32x32_bf16 a[240:255], a[164:167], v[116:123], v2
    s_add_u32 s30, s30, 8192
    s_addc_u32 s31, s31, 0
    v_exp_f32 v92, v92
    v_exp_f32 v93, v93
    v_exp_f32 v94, v94
    v_exp_f32_e64 v95, v95
    v_smfmac_f32_32x32x32_bf16 a[240:255], a[168:171], v[124:131], v2
    global_load_dwordx4 a[164:167], v3, s[28:29] offset:-3072 sc1
    v_exp_f32 v96, v96
    v_exp_f32 v97, v97
    v_exp_f32 v98, v98
    v_exp_f32 v99, v99
    v_mfma_f32_32x32x16_bf16 v[116:131], a[174:177], v[44:47], 0
    global_load_dwordx4 a[32:35], v22, s[30:31] offset:-4096 sc1
    v_exp_f32 v100, v100
    v_exp_f32 v101, v101
    v_exp_f32 v102, v102
    v_exp_f32 v103, v103
    v_mfma_f32_32x32x8_bf16 v[116:131], a[186:187], v[48:49], v[116:131]
    v_exp_f32 v104, v104
    v_exp_f32 v105, v105
    v_exp_f32 v106, v106
    v_exp_f32 v107, v107
    v_smfmac_f32_32x32x32_bf16 a[192:207], a[178:181], v[84:91], v2
    s_waitcnt vmcnt(18)
    global_load_dwordx4 a[168:171], v3, s[28:29] offset:-2304 sc1
    v_exp_f32 v108, v108
    v_exp_f32 v109, v109
    v_exp_f32 v110, v110
    v_exp_f32_e64 v111, v111
    v_smfmac_f32_32x32x32_bf16 a[192:207], a[182:185], v[92:99], v2
    s_add_u32 s52, s72, 17408
    s_addc_u32 s53, s73, 0
    v_exp_f32 v112, v112
    v_exp_f32 v113, v113
    v_exp_f32 v114, v114
    v_exp_f32_e64 v115, v115
    v_mfma_f32_32x32x16_bf16 v[84:99], a[174:177], v[50:53], 0
    s_add_u32 m0, s74, 12288
    v_exp_f32 v116, v116
    v_exp_f32 v117, v117
    v_exp_f32 v118, v118
    v_exp_f32 v119, v119
    v_mfma_f32_32x32x8_bf16 v[84:99], a[186:187], v[54:55], v[84:99]
    v_exp_f32 v120, v120
    v_exp_f32 v121, v121
    v_exp_f32 v122, v122
    v_exp_f32 v123, v123
    v_smfmac_f32_32x32x32_bf16 a[208:223], a[178:181], v[100:107], v2
    global_load_dwordx4 a[174:177], v1, s[28:29] offset:0 sc1
    v_exp_f32 v124, v124
    v_exp_f32 v125, v125
    v_exp_f32 v126, v126
    v_exp_f32 v127, v127
    v_smfmac_f32_32x32x32_bf16 a[208:223], a[182:185], v[108:115], v2
    global_load_lds_dwordx4 v1, s[52:53] offset:0 sc1
    v_exp_f32 v128, v128
    v_exp_f32 v129, v129
    v_exp_f32 v130, v130
    v_exp_f32 v131, v131
    v_mfma_f32_32x32x16_bf16 v[100:115], v[56:59], v[32:35], 0
    global_load_lds_dwordx4 v1, s[52:53] offset:1024 sc1
    v_exp_f32 v84, v84
    v_exp_f32 v85, v85
    v_exp_f32 v86, v86
    v_exp_f32 v87, v87
    v_mfma_f32_32x32x8_bf16 v[100:115], v[68:69], v[36:37], v[100:115]
    v_exp_f32 v88, v88
    v_exp_f32 v89, v89
    v_exp_f32 v90, v90
    v_exp_f32 v91, v91
    v_smfmac_f32_32x32x32_bf16 a[224:239], a[178:181], v[116:123], v2
    global_load_dwordx2 a[186:187], v4, s[28:29] offset:2560 sc1
    v_exp_f32 v92, v92
    v_exp_f32 v93, v93
    v_exp_f32 v94, v94
    v_exp_f32 v95, v95
    v_smfmac_f32_32x32x32_bf16 a[224:239], a[182:185], v[124:131], v2
    global_load_dwordx4 a[36:39], v23, s[30:31] offset:-4096 sc1
    v_exp_f32 v96, v96
    v_exp_f32 v97, v97
    v_exp_f32 v98, v98
    v_exp_f32 v99, v99
    v_mfma_f32_32x32x16_bf16 v[116:131], v[56:59], v[38:41], 0
    global_load_lds_dwordx4 v1, s[52:53] offset:2048 sc1
    v_exp_f32 v100, v100
    v_exp_f32 v101, v101
    v_exp_f32 v102, v102
    v_exp_f32 v103, v103
    v_mfma_f32_32x32x8_bf16 v[116:131], v[68:69], v[42:43], v[116:131]
    v_exp_f32 v104, v104
    v_exp_f32 v105, v105
    v_exp_f32 v106, v106
    v_exp_f32 v107, v107
    v_smfmac_f32_32x32x32_bf16 a[240:255], a[178:181], v[84:91], v2
    global_load_dwordx4 a[40:43], v24, s[30:31] offset:-4096 sc1
    v_exp_f32 v108, v108
    v_exp_f32 v109, v109
    v_exp_f32 v110, v110
    v_exp_f32 v111, v111
    v_smfmac_f32_32x32x32_bf16 a[240:255], a[182:185], v[92:99], v2
    global_load_dwordx4 a[178:181], v3, s[28:29] offset:1024 sc1
    v_exp_f32 v112, v112
    v_exp_f32 v113, v113
    v_exp_f32 v114, v114
    v_exp_f32 v115, v115
    v_mfma_f32_32x32x16_bf16 v[84:99], v[56:59], v[44:47], 0
    global_load_lds_dwordx4 v1, s[52:53] offset:3072 sc1
    v_exp_f32 v116, v116
    v_exp_f32 v117, v117
    v_exp_f32 v118, v118
    v_exp_f32 v119, v119
    v_mfma_f32_32x32x8_bf16 v[84:99], v[68:69], v[48:49], v[84:99]
    v_exp_f32 v120, v120
    v_exp_f32 v121, v121
    v_exp_f32 v122, v122
    v_exp_f32 v123, v123
    v_smfmac_f32_32x32x32_bf16 a[192:207], v[60:63], v[100:107], v2
    s_waitcnt vmcnt(18)
    global_load_dwordx4 a[182:185], v3, s[28:29] offset:1792 sc1
    v_exp_f32 v124, v124
    v_exp_f32 v125, v125
    v_exp_f32 v126, v126
    v_exp_f32_e64 v127, v127
    v_smfmac_f32_32x32x32_bf16 a[192:207], v[64:67], v[108:115], v2
    s_add_u32 s28, s28, 8192
    s_addc_u32 s29, s29, 0
    v_exp_f32 v128, v128
    v_exp_f32 v129, v129
    v_exp_f32 v130, v130
    v_exp_f32_e64 v131, v131
    v_mfma_f32_32x32x16_bf16 v[100:115], v[56:59], v[50:53], 0
    global_load_dwordx4 a[44:47], v25, s[30:31] offset:-4096 sc1
    v_exp_f32 v84, v84
    v_exp_f32 v85, v85
    v_exp_f32 v86, v86
    v_exp_f32 v87, v87
    v_mfma_f32_32x32x8_bf16 v[100:115], v[68:69], v[54:55], v[100:115]
    v_exp_f32 v88, v88
    v_exp_f32 v89, v89
    v_exp_f32 v90, v90
    v_exp_f32 v91, v91
    v_smfmac_f32_32x32x32_bf16 a[208:223], v[60:63], v[116:123], v2
    global_load_dwordx4 v[56:59], v1, s[28:29] offset:-4096 sc1
    v_exp_f32 v92, v92
    v_exp_f32 v93, v93
    v_exp_f32 v94, v94
    v_exp_f32 v95, v95
    v_smfmac_f32_32x32x32_bf16 a[208:223], v[64:67], v[124:131], v2
    s_add_u32 s52, s72, 21504
    s_addc_u32 s53, s73, 0
    v_exp_f32 v96, v96
    v_exp_f32 v97, v97
    v_exp_f32 v98, v98
    v_exp_f32_e64 v99, v99
    v_mfma_f32_32x32x16_bf16 v[116:131], v[70:73], v[32:35], 0
    s_add_u32 m0, s74, 16384
    v_exp_f32 v100, v100
    v_exp_f32 v101, v101
    v_exp_f32 v102, v102
    v_exp_f32 v103, v103
    v_mfma_f32_32x32x8_bf16 v[116:131], v[82:83], v[36:37], v[116:131]
    v_exp_f32 v104, v104
    v_exp_f32 v105, v105
    v_exp_f32 v106, v106
    v_exp_f32 v107, v107
    v_smfmac_f32_32x32x32_bf16 a[224:239], v[60:63], v[84:91], v2
    global_load_dwordx2 v[68:69], v4, s[28:29] offset:-1536 sc1
    v_exp_f32 v108, v108
    v_exp_f32 v109, v109
    v_exp_f32 v110, v110
    v_exp_f32 v111, v111
    v_smfmac_f32_32x32x32_bf16 a[224:239], v[64:67], v[92:99], v2
    global_load_lds_dwordx4 v1, s[52:53] offset:0 sc1
    v_exp_f32 v112, v112
    v_exp_f32 v113, v113
    v_exp_f32 v114, v114
    v_exp_f32 v115, v115
    v_mfma_f32_32x32x16_bf16 v[84:99], v[70:73], v[38:41], 0
    global_load_lds_dwordx4 v1, s[52:53] offset:1024 sc1
    v_exp_f32 v116, v116
    v_exp_f32 v117, v117
    v_exp_f32 v118, v118
    v_exp_f32 v119, v119
    v_mfma_f32_32x32x8_bf16 v[84:99], v[82:83], v[42:43], v[84:99]
    v_exp_f32 v120, v120
    v_exp_f32 v121, v121
    v_exp_f32 v122, v122
    v_exp_f32 v123, v123
    v_smfmac_f32_32x32x32_bf16 a[240:255], v[60:63], v[100:107], v2
    global_load_lds_dwordx4 v1, s[52:53] offset:2048 sc1
    v_exp_f32 v124, v124
    v_exp_f32 v125, v125
    v_exp_f32 v126, v126
    v_exp_f32 v127, v127
    v_smfmac_f32_32x32x32_bf16 a[240:255], v[64:67], v[108:115], v2
    global_load_dwordx4 v[60:63], v3, s[28:29] offset:-3072 sc1
    v_exp_f32 v128, v128
    v_exp_f32 v129, v129
    v_exp_f32 v130, v130
    v_exp_f32 v131, v131
    v_mfma_f32_32x32x16_bf16 v[100:115], v[70:73], v[44:47], 0
    global_load_dwordx4 a[48:51], v22, s[30:31] offset:0 sc1
    v_exp_f32 v84, v84
    v_exp_f32 v85, v85
    v_exp_f32 v86, v86
    v_exp_f32 v87, v87
    v_mfma_f32_32x32x8_bf16 v[100:115], v[82:83], v[48:49], v[100:115]
    v_exp_f32 v88, v88
    v_exp_f32 v89, v89
    v_exp_f32 v90, v90
    v_exp_f32 v91, v91
    v_smfmac_f32_32x32x32_bf16 a[192:207], v[74:77], v[116:123], v2
    s_waitcnt vmcnt(18)
    global_load_dwordx4 v[64:67], v3, s[28:29] offset:-2304 sc1
    v_exp_f32 v92, v92
    v_exp_f32 v93, v93
    v_exp_f32 v94, v94
    v_exp_f32_e64 v95, v95
    v_smfmac_f32_32x32x32_bf16 a[192:207], v[78:81], v[124:131], v2
    global_load_lds_dwordx4 v1, s[52:53] offset:3072 sc1
    v_exp_f32 v96, v96
    v_exp_f32 v97, v97
    v_exp_f32 v98, v98
    v_exp_f32 v99, v99
    v_mfma_f32_32x32x16_bf16 v[116:131], v[70:73], v[50:53], 0
    global_load_dwordx4 a[52:55], v23, s[30:31] offset:0 sc1
    v_exp_f32 v100, v100
    v_exp_f32 v101, v101
    v_exp_f32 v102, v102
    v_exp_f32 v103, v103
    v_mfma_f32_32x32x8_bf16 v[116:131], v[82:83], v[54:55], v[116:131]
    v_exp_f32 v104, v104
    v_exp_f32 v105, v105
    v_exp_f32 v106, v106
    v_exp_f32 v107, v107
    v_smfmac_f32_32x32x32_bf16 a[208:223], v[74:77], v[84:91], v2
    global_load_dwordx4 v[70:73], v1, s[28:29] offset:0 sc1
    v_exp_f32 v108, v108
    v_exp_f32 v109, v109
    v_exp_f32 v110, v110
    v_exp_f32 v111, v111
    v_smfmac_f32_32x32x32_bf16 a[208:223], v[78:81], v[92:99], v2
    s_add_u32 s52, s72, 25600
    s_addc_u32 s53, s73, 0
    v_exp_f32 v112, v112
    v_exp_f32 v113, v113
    v_exp_f32 v114, v114
    v_exp_f32_e64 v115, v115
    v_mfma_f32_32x32x16_bf16 v[84:99], a[160:163], v[32:35], 0
    s_add_u32 m0, s74, 20480
    v_exp_f32 v116, v116
    v_exp_f32 v117, v117
    v_exp_f32 v118, v118
    v_exp_f32 v119, v119
    v_mfma_f32_32x32x8_bf16 v[84:99], a[172:173], v[36:37], v[84:99]
    v_exp_f32 v120, v120
    v_exp_f32 v121, v121
    v_exp_f32 v122, v122
    v_exp_f32 v123, v123
    v_smfmac_f32_32x32x32_bf16 a[224:239], v[74:77], v[100:107], v2
    global_load_dwordx2 v[82:83], v4, s[28:29] offset:2560 sc1
    v_exp_f32 v124, v124
    v_exp_f32 v125, v125
    v_exp_f32 v126, v126
    v_exp_f32 v127, v127
    v_smfmac_f32_32x32x32_bf16 a[224:239], v[78:81], v[108:115], v2
    global_load_lds_dwordx4 v1, s[52:53] offset:0 sc1
    v_exp_f32 v128, v128
    v_exp_f32 v129, v129
    v_exp_f32 v130, v130
    v_exp_f32 v131, v131
    v_mfma_f32_32x32x16_bf16 v[100:115], a[160:163], v[38:41], 0
    global_load_dwordx4 a[56:59], v24, s[30:31] offset:0 sc1
    v_exp_f32 v84, v84
    v_exp_f32 v85, v85
    v_exp_f32 v86, v86
    v_exp_f32 v87, v87
    v_mfma_f32_32x32x8_bf16 v[100:115], a[172:173], v[42:43], v[100:115]
    v_exp_f32 v88, v88
    v_exp_f32 v89, v89
    v_exp_f32 v90, v90
    v_exp_f32 v91, v91
    v_smfmac_f32_32x32x32_bf16 a[240:255], v[74:77], v[116:123], v2
    global_load_lds_dwordx4 v1, s[52:53] offset:1024 sc1
    v_exp_f32 v92, v92
    v_exp_f32 v93, v93
    v_exp_f32 v94, v94
    v_exp_f32 v95, v95
    v_smfmac_f32_32x32x32_bf16 a[240:255], v[78:81], v[124:131], v2
    global_load_dwordx4 v[74:77], v3, s[28:29] offset:1024 sc1
    v_exp_f32 v96, v96
    v_exp_f32 v97, v97
    v_exp_f32 v98, v98
    v_exp_f32 v99, v99
    v_mfma_f32_32x32x16_bf16 v[116:131], a[160:163], v[44:47], 0
    global_load_lds_dwordx4 v1, s[52:53] offset:2048 sc1
    v_exp_f32 v100, v100
    v_exp_f32 v101, v101
    v_exp_f32 v102, v102
    v_exp_f32 v103, v103
    v_mfma_f32_32x32x8_bf16 v[116:131], a[172:173], v[48:49], v[116:131]
    v_exp_f32 v104, v104
    v_exp_f32 v105, v105
    v_exp_f32 v106, v106
    v_exp_f32 v107, v107
    v_smfmac_f32_32x32x32_bf16 a[192:207], a[164:167], v[84:91], v2
    s_waitcnt vmcnt(18)
    global_load_dwordx4 v[78:81], v3, s[28:29] offset:1792 sc1
    v_exp_f32 v108, v108
    v_exp_f32 v109, v109
    v_exp_f32 v110, v110
    v_exp_f32_e64 v111, v111
    v_smfmac_f32_32x32x32_bf16 a[192:207], a[168:171], v[92:99], v2
    s_add_u32 s28, s28, 8192
    s_addc_u32 s29, s29, 0
    v_exp_f32 v112, v112
    v_exp_f32 v113, v113
    v_exp_f32 v114, v114
    v_exp_f32_e64 v115, v115
    v_mfma_f32_32x32x16_bf16 v[84:99], a[160:163], v[50:53], 0
    global_load_dwordx4 a[60:63], v25, s[30:31] offset:0 sc1
    v_exp_f32 v116, v116
    v_exp_f32 v117, v117
    v_exp_f32 v118, v118
    v_exp_f32 v119, v119
    v_mfma_f32_32x32x8_bf16 v[84:99], a[172:173], v[54:55], v[84:99]
    v_exp_f32 v120, v120
    v_exp_f32 v121, v121
    v_exp_f32 v122, v122
    v_exp_f32 v123, v123
    v_smfmac_f32_32x32x32_bf16 a[208:223], a[164:167], v[100:107], v2
    global_load_dwordx4 a[160:163], v1, s[28:29] offset:-4096 sc1
    v_exp_f32 v124, v124
    v_exp_f32 v125, v125
    v_exp_f32 v126, v126
    v_exp_f32 v127, v127
    v_smfmac_f32_32x32x32_bf16 a[208:223], a[168:171], v[108:115], v2
    global_load_lds_dwordx4 v1, s[52:53] offset:3072 sc1
    v_exp_f32 v128, v128
    v_exp_f32 v129, v129
    v_exp_f32 v130, v130
    v_exp_f32 v131, v131
    v_mfma_f32_32x32x16_bf16 v[100:115], a[174:177], v[32:35], 0
    v_exp_f32 v84, v84
    v_exp_f32 v85, v85
    v_exp_f32 v86, v86
    v_exp_f32 v87, v87
    v_mfma_f32_32x32x8_bf16 v[100:115], a[186:187], v[36:37], v[100:115]
    v_exp_f32 v88, v88
    v_exp_f32 v89, v89
    v_exp_f32 v90, v90
    v_exp_f32 v91, v91
    v_smfmac_f32_32x32x32_bf16 a[224:239], a[164:167], v[116:123], v2
    global_load_dwordx2 a[172:173], v4, s[28:29] offset:-1536 sc1
    v_exp_f32 v92, v92
    v_exp_f32 v93, v93
    v_exp_f32 v94, v94
    v_exp_f32 v95, v95
    v_smfmac_f32_32x32x32_bf16 a[224:239], a[168:171], v[124:131], v2
    s_add_u32 s30, s30, 8192
    s_addc_u32 s31, s31, 0
    v_exp_f32 v96, v96
    v_exp_f32 v97, v97
    v_exp_f32 v98, v98
    v_exp_f32_e64 v99, v99
    v_mfma_f32_32x32x16_bf16 v[116:131], a[174:177], v[38:41], 0
    global_load_dwordx4 a[64:67], v22, s[30:31] offset:-4096 sc1
    v_exp_f32 v100, v100
    v_exp_f32 v101, v101
    v_exp_f32 v102, v102
    v_exp_f32 v103, v103
    v_mfma_f32_32x32x8_bf16 v[116:131], a[186:187], v[42:43], v[116:131]
    v_exp_f32 v104, v104
    v_exp_f32 v105, v105
    v_exp_f32 v106, v106
    v_exp_f32 v107, v107
    v_smfmac_f32_32x32x32_bf16 a[240:255], a[164:167], v[84:91], v2
    s_add_u32 s52, s72, 29696
    s_addc_u32 s53, s73, 0
    v_exp_f32 v108, v108
    v_exp_f32 v109, v109
    v_exp_f32 v110, v110
    v_exp_f32_e64 v111, v111
    v_smfmac_f32_32x32x32_bf16 a[240:255], a[168:171], v[92:99], v2
    s_add_u32 m0, s74, 24576
    global_load_dwordx4 a[164:167], v3, s[28:29] offset:-3072 sc1
    v_exp_f32 v112, v112
    v_exp_f32 v113, v113
    v_exp_f32 v114, v114
    v_exp_f32 v115, v115
    v_mfma_f32_32x32x16_bf16 v[84:99], a[174:177], v[44:47], 0
    global_load_lds_dwordx4 v1, s[52:53] offset:0 sc1
    v_exp_f32 v116, v116
    v_exp_f32 v117, v117
    v_exp_f32 v118, v118
    v_exp_f32 v119, v119
    v_mfma_f32_32x32x8_bf16 v[84:99], a[186:187], v[48:49], v[84:99]
    v_exp_f32 v120, v120
    v_exp_f32 v121, v121
    v_exp_f32 v122, v122
    v_exp_f32 v123, v123
    v_smfmac_f32_32x32x32_bf16 a[192:207], a[178:181], v[100:107], v2
    s_waitcnt vmcnt(17)
    global_load_dwordx4 a[168:171], v3, s[28:29] offset:-2304 sc1
    v_exp_f32 v124, v124
    v_exp_f32 v125, v125
    v_exp_f32 v126, v126
    v_exp_f32_e64 v127, v127
    v_smfmac_f32_32x32x32_bf16 a[192:207], a[182:185], v[108:115], v2
    global_load_lds_dwordx4 v1, s[52:53] offset:1024 sc1
    v_exp_f32 v128, v128
    v_exp_f32 v129, v129
    v_exp_f32 v130, v130
    v_exp_f32 v131, v131
    v_mfma_f32_32x32x16_bf16 v[100:115], a[174:177], v[50:53], 0
    global_load_dwordx4 a[68:71], v23, s[30:31] offset:-4096 sc1
    v_exp_f32 v84, v84
    v_exp_f32 v85, v85
    v_exp_f32 v86, v86
    v_exp_f32 v87, v87
    v_mfma_f32_32x32x8_bf16 v[100:115], a[186:187], v[54:55], v[100:115]
    v_exp_f32 v88, v88
    v_exp_f32 v89, v89
    v_exp_f32 v90, v90
    v_exp_f32 v91, v91
    v_smfmac_f32_32x32x32_bf16 a[208:223], a[178:181], v[116:123], v2
    global_load_dwordx4 a[174:177], v1, s[28:29] offset:0 sc1
    v_exp_f32 v92, v92
    v_exp_f32 v93, v93
    v_exp_f32 v94, v94
    v_exp_f32 v95, v95
    v_smfmac_f32_32x32x32_bf16 a[208:223], a[182:185], v[124:131], v2
    global_load_lds_dwordx4 v1, s[52:53] offset:2048 sc1
    v_exp_f32 v96, v96
    v_exp_f32 v97, v97
    v_exp_f32 v98, v98
    v_exp_f32 v99, v99
    v_mfma_f32_32x32x16_bf16 v[116:131], v[56:59], v[32:35], 0
    global_load_dwordx4 a[72:75], v24, s[30:31] offset:-4096 sc1
    v_exp_f32 v100, v100
    v_exp_f32 v101, v101
    v_exp_f32 v102, v102
    v_exp_f32 v103, v103
    v_mfma_f32_32x32x8_bf16 v[116:131], v[68:69], v[36:37], v[116:131]
    v_exp_f32 v104, v104
    v_exp_f32 v105, v105
    v_exp_f32 v106, v106
    v_exp_f32 v107, v107
    v_smfmac_f32_32x32x32_bf16 a[224:239], a[178:181], v[84:91], v2
    global_load_dwordx2 a[186:187], v4, s[28:29] offset:2560 sc1
    v_exp_f32 v108, v108
    v_exp_f32 v109, v109
    v_exp_f32 v110, v110
    v_exp_f32 v111, v111
    v_smfmac_f32_32x32x32_bf16 a[224:239], a[182:185], v[92:99], v2
    global_load_lds_dwordx4 v1, s[52:53] offset:3072 sc1
    v_exp_f32 v112, v112
    v_exp_f32 v113, v113
    v_exp_f32 v114, v114
    v_exp_f32 v115, v115
    v_mfma_f32_32x32x16_bf16 v[84:99], v[56:59], v[38:41], 0
    v_exp_f32 v116, v116
    v_exp_f32 v117, v117
    v_exp_f32 v118, v118
    v_exp_f32 v119, v119
    v_mfma_f32_32x32x8_bf16 v[84:99], v[68:69], v[42:43], v[84:99]
    v_exp_f32 v120, v120
    v_exp_f32 v121, v121
    v_exp_f32 v122, v122
    v_exp_f32 v123, v123
    v_smfmac_f32_32x32x32_bf16 a[240:255], a[178:181], v[100:107], v2
    s_add_u32 s52, s72, 33792
    s_addc_u32 s53, s73, 0
    v_exp_f32 v124, v124
    v_exp_f32 v125, v125
    v_exp_f32 v126, v126
    v_exp_f32_e64 v127, v127
    v_smfmac_f32_32x32x32_bf16 a[240:255], a[182:185], v[108:115], v2
    s_add_u32 m0, s74, 28672
    global_load_dwordx4 a[178:181], v3, s[28:29] offset:1024 sc1
    v_exp_f32 v128, v128
    v_exp_f32 v129, v129
    v_exp_f32 v130, v130
    v_exp_f32 v131, v131
    v_mfma_f32_32x32x16_bf16 v[100:115], v[56:59], v[44:47], 0
    global_load_lds_dwordx4 v1, s[52:53] offset:0 sc1
    v_exp_f32 v84, v84
    v_exp_f32 v85, v85
    v_exp_f32 v86, v86
    v_exp_f32 v87, v87
    v_mfma_f32_32x32x8_bf16 v[100:115], v[68:69], v[48:49], v[100:115]
    v_exp_f32 v88, v88
    v_exp_f32 v89, v89
    v_exp_f32 v90, v90
    v_exp_f32 v91, v91
    v_smfmac_f32_32x32x32_bf16 a[192:207], v[60:63], v[116:123], v2
    s_waitcnt vmcnt(17)
    global_load_dwordx4 a[182:185], v3, s[28:29] offset:1792 sc1
    v_exp_f32 v92, v92
    v_exp_f32 v93, v93
    v_exp_f32 v94, v94
    v_exp_f32_e64 v95, v95
    v_smfmac_f32_32x32x32_bf16 a[192:207], v[64:67], v[124:131], v2
    s_add_u32 s28, s28, 8192
    s_addc_u32 s29, s29, 0
    v_exp_f32 v96, v96
    v_exp_f32 v97, v97
    v_exp_f32 v98, v98
    v_exp_f32_e64 v99, v99
    v_mfma_f32_32x32x16_bf16 v[116:131], v[56:59], v[50:53], 0
    global_load_dwordx4 a[76:79], v25, s[30:31] offset:-4096 sc1
    v_exp_f32 v100, v100
    v_exp_f32 v101, v101
    v_exp_f32 v102, v102
    v_exp_f32 v103, v103
    v_mfma_f32_32x32x8_bf16 v[116:131], v[68:69], v[54:55], v[116:131]
    v_exp_f32 v104, v104
    v_exp_f32 v105, v105
    v_exp_f32 v106, v106
    v_exp_f32 v107, v107
    v_smfmac_f32_32x32x32_bf16 a[208:223], v[60:63], v[84:91], v2
    global_load_dwordx4 v[56:59], v1, s[28:29] offset:-4096 sc1
    v_exp_f32 v108, v108
    v_exp_f32 v109, v109
    v_exp_f32 v110, v110
    v_exp_f32 v111, v111
    v_smfmac_f32_32x32x32_bf16 a[208:223], v[64:67], v[92:99], v2
    global_load_lds_dwordx4 v1, s[52:53] offset:1024 sc1
    v_exp_f32 v112, v112
    v_exp_f32 v113, v113
    v_exp_f32 v114, v114
    v_exp_f32 v115, v115
    v_mfma_f32_32x32x16_bf16 v[84:99], v[70:73], v[32:35], 0
    global_load_dwordx4 a[80:83], v22, s[30:31] offset:0 sc1
    v_exp_f32 v116, v116
    v_exp_f32 v117, v117
    v_exp_f32 v118, v118
    v_exp_f32 v119, v119
    v_mfma_f32_32x32x8_bf16 v[84:99], v[82:83], v[36:37], v[84:99]
    v_exp_f32 v120, v120
    v_exp_f32 v121, v121
    v_exp_f32 v122, v122
    v_exp_f32 v123, v123
    v_smfmac_f32_32x32x32_bf16 a[224:239], v[60:63], v[100:107], v2
    global_load_dwordx2 v[68:69], v4, s[28:29] offset:-1536 sc1
    v_exp_f32 v124, v124
    v_exp_f32 v125, v125
    v_exp_f32 v126, v126
    v_exp_f32 v127, v127
    v_smfmac_f32_32x32x32_bf16 a[224:239], v[64:67], v[108:115], v2
    s_add_u32 s52, s72, 4096
    s_addc_u32 s53, s73, 0
    v_exp_f32 v128, v128
    v_exp_f32 v129, v129
    v_exp_f32 v130, v130
    v_exp_f32_e64 v131, v131
    v_mfma_f32_32x32x16_bf16 v[100:115], v[70:73], v[38:41], 0
    global_load_dwordx4 v[132:135], v1, s[52:53] offset:-4096 sc1
    v_exp_f32 v84, v84
    v_exp_f32 v85, v85
    v_exp_f32 v86, v86
    v_exp_f32 v87, v87
    v_mfma_f32_32x32x8_bf16 v[100:115], v[82:83], v[42:43], v[100:115]
    v_exp_f32 v88, v88
    v_exp_f32 v89, v89
    v_exp_f32 v90, v90
    v_exp_f32 v91, v91
    v_smfmac_f32_32x32x32_bf16 a[240:255], v[60:63], v[116:123], v2
    global_load_dwordx4 v[136:139], v1, s[52:53] offset:-3072 sc1
    v_exp_f32 v92, v92
    v_exp_f32 v93, v93
    v_exp_f32 v94, v94
    v_exp_f32 v95, v95
    v_smfmac_f32_32x32x32_bf16 a[240:255], v[64:67], v[124:131], v2
    global_load_dwordx4 v[60:63], v3, s[28:29] offset:-3072 sc1
    v_exp_f32 v96, v96
    v_exp_f32 v97, v97
    v_exp_f32 v98, v98
    v_exp_f32 v99, v99
    v_mfma_f32_32x32x16_bf16 v[116:131], v[70:73], v[44:47], 0
    global_load_dwordx4 a[84:87], v23, s[30:31] offset:0 sc1
    v_exp_f32 v100, v100
    v_exp_f32 v101, v101
    v_exp_f32 v102, v102
    v_exp_f32 v103, v103
    v_mfma_f32_32x32x8_bf16 v[116:131], v[82:83], v[48:49], v[116:131]
    v_exp_f32 v104, v104
    v_exp_f32 v105, v105
    v_exp_f32 v106, v106
    v_exp_f32 v107, v107
    v_smfmac_f32_32x32x32_bf16 a[192:207], v[74:77], v[84:91], v2
    s_waitcnt vmcnt(19)
    global_load_dwordx4 v[64:67], v3, s[28:29] offset:-2304 sc1
    v_exp_f32 v108, v108
    v_exp_f32 v109, v109
    v_exp_f32 v110, v110
    v_exp_f32_e64 v111, v111
    v_smfmac_f32_32x32x32_bf16 a[192:207], v[78:81], v[92:99], v2
    global_load_dwordx4 v[140:143], v1, s[52:53] offset:-2048 sc1
    v_exp_f32 v112, v112
    v_exp_f32 v113, v113
    v_exp_f32 v114, v114
    v_exp_f32 v115, v115
    v_mfma_f32_32x32x16_bf16 v[84:99], v[70:73], v[50:53], 0
    v_exp_f32 v116, v116
    v_exp_f32 v117, v117
    v_exp_f32 v118, v118
    v_exp_f32 v119, v119
    v_mfma_f32_32x32x8_bf16 v[84:99], v[82:83], v[54:55], v[84:99]
    v_exp_f32 v120, v120
    v_exp_f32 v121, v121
    v_exp_f32 v122, v122
    v_exp_f32 v123, v123
    v_smfmac_f32_32x32x32_bf16 a[208:223], v[74:77], v[100:107], v2
    global_load_dwordx4 v[70:73], v1, s[28:29] offset:0 sc1
    v_exp_f32 v124, v124
    v_exp_f32 v125, v125
    v_exp_f32 v126, v126
    v_exp_f32 v127, v127
    v_smfmac_f32_32x32x32_bf16 a[208:223], v[78:81], v[108:115], v2
    global_load_dwordx4 a[88:91], v24, s[30:31] offset:0 sc1
    v_exp_f32 v128, v128
    v_exp_f32 v129, v129
    v_exp_f32 v130, v130
    v_exp_f32 v131, v131
    v_mfma_f32_32x32x16_bf16 v[100:115], a[160:163], v[32:35], 0
    global_load_dwordx4 v[144:147], v1, s[52:53] offset:-1024 sc1
    v_exp_f32 v84, v84
    v_exp_f32 v85, v85
    v_exp_f32 v86, v86
    v_exp_f32 v87, v87
    v_mfma_f32_32x32x8_bf16 v[100:115], a[172:173], v[36:37], v[100:115]
    v_exp_f32 v88, v88
    v_exp_f32 v89, v89
    v_exp_f32 v90, v90
    v_exp_f32 v91, v91
    v_smfmac_f32_32x32x32_bf16 a[224:239], v[74:77], v[116:123], v2
    global_load_dwordx2 v[82:83], v4, s[28:29] offset:2560 sc1
    v_exp_f32 v92, v92
    v_exp_f32 v93, v93
    v_exp_f32 v94, v94
    v_exp_f32 v95, v95
    v_smfmac_f32_32x32x32_bf16 a[224:239], v[78:81], v[124:131], v2
    v_exp_f32 v96, v96
    v_exp_f32 v97, v97
    v_exp_f32 v98, v98
    v_exp_f32 v99, v99
    v_mfma_f32_32x32x16_bf16 v[116:131], a[160:163], v[38:41], 0
    global_load_dwordx4 v[148:151], v1, s[52:53] offset:0 sc1
    v_exp_f32 v100, v100
    v_exp_f32 v101, v101
    v_exp_f32 v102, v102
    v_exp_f32 v103, v103
    v_mfma_f32_32x32x8_bf16 v[116:131], a[172:173], v[42:43], v[116:131]
    v_exp_f32 v104, v104
    v_exp_f32 v105, v105
    v_exp_f32 v106, v106
    v_exp_f32 v107, v107
    v_smfmac_f32_32x32x32_bf16 a[240:255], v[74:77], v[84:91], v2
    global_load_dwordx4 a[92:95], v25, s[30:31] offset:0 sc1
    v_exp_f32 v108, v108
    v_exp_f32 v109, v109
    v_exp_f32 v110, v110
    v_exp_f32 v111, v111
    v_smfmac_f32_32x32x32_bf16 a[240:255], v[78:81], v[92:99], v2
    global_load_dwordx4 v[74:77], v3, s[28:29] offset:1024 sc1
    v_exp_f32 v112, v112
    v_exp_f32 v113, v113
    v_exp_f32 v114, v114
    v_exp_f32 v115, v115
    v_mfma_f32_32x32x16_bf16 v[84:99], a[160:163], v[44:47], 0
    v_exp_f32 v116, v116
    v_exp_f32 v117, v117
    v_exp_f32 v118, v118
    v_exp_f32 v119, v119
    v_mfma_f32_32x32x8_bf16 v[84:99], a[172:173], v[48:49], v[84:99]
    v_exp_f32 v120, v120
    v_exp_f32 v121, v121
    v_exp_f32 v122, v122
    v_exp_f32 v123, v123
    v_smfmac_f32_32x32x32_bf16 a[192:207], a[164:167], v[100:107], v2
    s_waitcnt vmcnt(18)
    global_load_dwordx4 v[78:81], v3, s[28:29] offset:1792 sc1
    v_exp_f32 v124, v124
    v_exp_f32 v125, v125
    v_exp_f32 v126, v126
    v_exp_f32_e64 v127, v127
    v_smfmac_f32_32x32x32_bf16 a[192:207], a[168:171], v[108:115], v2
    s_add_u32 s28, s28, 8192
    s_addc_u32 s29, s29, 0
    v_exp_f32 v128, v128
    v_exp_f32 v129, v129
    v_exp_f32 v130, v130
    v_exp_f32_e64 v131, v131
    v_mfma_f32_32x32x16_bf16 v[100:115], a[160:163], v[50:53], 0
    v_exp_f32 v84, v84
    v_exp_f32 v85, v85
    v_exp_f32 v86, v86
    v_exp_f32 v87, v87
    v_mfma_f32_32x32x8_bf16 v[100:115], a[172:173], v[54:55], v[100:115]
    v_exp_f32 v88, v88
    v_exp_f32 v89, v89
    v_exp_f32 v90, v90
    v_exp_f32 v91, v91
    v_smfmac_f32_32x32x32_bf16 a[208:223], a[164:167], v[116:123], v2
    global_load_dwordx4 a[160:163], v1, s[28:29] offset:-4096 sc1
    v_exp_f32 v92, v92
    v_exp_f32 v93, v93
    v_exp_f32 v94, v94
    v_exp_f32 v95, v95
    v_smfmac_f32_32x32x32_bf16 a[208:223], a[168:171], v[124:131], v2
    s_add_u32 s52, s72, 39936
    s_addc_u32 s53, s73, 0
    v_exp_f32 v96, v96
    v_exp_f32 v97, v97
    v_exp_f32 v98, v98
    v_exp_f32_e64 v99, v99
    v_mfma_f32_32x32x16_bf16 v[116:131], a[174:177], v[32:35], 0
    global_load_dwordx4 v[152:155], v1, s[52:53] offset:-4096 sc1
    v_exp_f32 v100, v100
    v_exp_f32 v101, v101
    v_exp_f32 v102, v102
    v_exp_f32 v103, v103
    v_mfma_f32_32x32x8_bf16 v[116:131], a[186:187], v[36:37], v[116:131]
    v_exp_f32 v104, v104
    v_exp_f32 v105, v105
    v_exp_f32 v106, v106
    v_exp_f32 v107, v107
    v_smfmac_f32_32x32x32_bf16 a[224:239], a[164:167], v[84:91], v2
    global_load_dwordx2 a[172:173], v4, s[28:29] offset:-1536 sc1
    v_exp_f32 v108, v108
    v_exp_f32 v109, v109
    v_exp_f32 v110, v110
    v_exp_f32 v111, v111
    v_smfmac_f32_32x32x32_bf16 a[224:239], a[168:171], v[92:99], v2
    global_load_dwordx4 v[156:159], v1, s[52:53] offset:-3072 sc1
    v_exp_f32 v112, v112
    v_exp_f32 v113, v113
    v_exp_f32 v114, v114
    v_exp_f32 v115, v115
    v_mfma_f32_32x32x16_bf16 v[84:99], a[174:177], v[38:41], 0
    global_load_dwordx4 v[160:163], v1, s[52:53] offset:-2048 sc1
    v_exp_f32 v116, v116
    v_exp_f32 v117, v117
    v_exp_f32 v118, v118
    v_exp_f32 v119, v119
    v_mfma_f32_32x32x8_bf16 v[84:99], a[186:187], v[42:43], v[84:99]
    v_exp_f32 v120, v120
    v_exp_f32 v121, v121
    v_exp_f32 v122, v122
    v_exp_f32 v123, v123
    v_smfmac_f32_32x32x32_bf16 a[240:255], a[164:167], v[100:107], v2
    s_add_u32 s30, s30, 8192
    s_addc_u32 s31, s31, 0
    v_exp_f32 v124, v124
    v_exp_f32 v125, v125
    v_exp_f32 v126, v126
    v_exp_f32_e64 v127, v127
    v_smfmac_f32_32x32x32_bf16 a[240:255], a[168:171], v[108:115], v2
    global_load_dwordx4 a[164:167], v3, s[28:29] offset:-3072 sc1
    v_exp_f32 v128, v128
    v_exp_f32 v129, v129
    v_exp_f32 v130, v130
    v_exp_f32 v131, v131
    v_mfma_f32_32x32x16_bf16 v[100:115], a[174:177], v[44:47], 0
    global_load_dwordx4 a[96:99], v22, s[30:31] offset:-4096 sc1
    v_exp_f32 v84, v84
    v_exp_f32 v85, v85
    v_exp_f32 v86, v86
    v_exp_f32 v87, v87
    v_mfma_f32_32x32x8_bf16 v[100:115], a[186:187], v[48:49], v[100:115]
    v_exp_f32 v88, v88
    v_exp_f32 v89, v89
    v_exp_f32 v90, v90
    v_exp_f32 v91, v91
    v_smfmac_f32_32x32x32_bf16 a[192:207], a[178:181], v[116:123], v2
    s_waitcnt vmcnt(16)
    global_load_dwordx4 a[168:171], v3, s[28:29] offset:-2304 sc1
    v_exp_f32 v92, v92
    v_exp_f32 v93, v93
    v_exp_f32 v94, v94
    v_exp_f32_e64 v95, v95
    v_smfmac_f32_32x32x32_bf16 a[192:207], a[182:185], v[124:131], v2
    global_load_dwordx4 a[100:103], v23, s[30:31] offset:-4096 sc1
    v_exp_f32 v96, v96
    v_exp_f32 v97, v97
    v_exp_f32 v98, v98
    v_exp_f32 v99, v99
    v_mfma_f32_32x32x16_bf16 v[116:131], a[174:177], v[50:53], 0
    global_load_dwordx4 v[164:167], v1, s[52:53] offset:-1024 sc1
    v_exp_f32 v100, v100
    v_exp_f32 v101, v101
    v_exp_f32 v102, v102
    v_exp_f32 v103, v103
    v_mfma_f32_32x32x8_bf16 v[116:131], a[186:187], v[54:55], v[116:131]
    v_exp_f32 v104, v104
    v_exp_f32 v105, v105
    v_exp_f32 v106, v106
    v_exp_f32 v107, v107
    v_smfmac_f32_32x32x32_bf16 a[208:223], a[178:181], v[84:91], v2
    global_load_dwordx4 a[174:177], v1, s[28:29] offset:0 sc1
    v_exp_f32 v108, v108
    v_exp_f32 v109, v109
    v_exp_f32 v110, v110
    v_exp_f32 v111, v111
    v_smfmac_f32_32x32x32_bf16 a[208:223], a[182:185], v[92:99], v2
    global_load_dwordx4 v[168:171], v1, s[52:53] offset:0 sc1
    v_exp_f32 v112, v112
    v_exp_f32 v113, v113
    v_exp_f32 v114, v114
    v_exp_f32 v115, v115
    v_mfma_f32_32x32x16_bf16 v[84:99], v[56:59], v[32:35], 0
    global_load_dwordx4 a[104:107], v24, s[30:31] offset:-4096 sc1
    v_exp_f32 v116, v116
    v_exp_f32 v117, v117
    v_exp_f32 v118, v118
    v_exp_f32 v119, v119
    v_mfma_f32_32x32x8_bf16 v[84:99], v[68:69], v[36:37], v[84:99]
    v_exp_f32 v120, v120
    v_exp_f32 v121, v121
    v_exp_f32 v122, v122
    v_exp_f32 v123, v123
    v_smfmac_f32_32x32x32_bf16 a[224:239], a[178:181], v[100:107], v2
    global_load_dwordx2 a[186:187], v4, s[28:29] offset:2560 sc1
    v_exp_f32 v124, v124
    v_exp_f32 v125, v125
    v_exp_f32 v126, v126
    v_exp_f32 v127, v127
    v_smfmac_f32_32x32x32_bf16 a[224:239], a[182:185], v[108:115], v2
    global_load_dwordx4 v[172:175], v1, s[52:53] offset:1024 sc1
    v_exp_f32 v128, v128
    v_exp_f32 v129, v129
    v_exp_f32 v130, v130
    v_exp_f32 v131, v131
    v_mfma_f32_32x32x16_bf16 v[100:115], v[56:59], v[38:41], 0
    global_load_dwordx4 a[108:111], v25, s[30:31] offset:-4096 sc1
    v_exp_f32 v84, v84
    v_exp_f32 v85, v85
    v_exp_f32 v86, v86
    v_exp_f32 v87, v87
    v_mfma_f32_32x32x8_bf16 v[100:115], v[68:69], v[42:43], v[100:115]
    v_exp_f32 v88, v88
    v_exp_f32 v89, v89
    v_exp_f32 v90, v90
    v_exp_f32 v91, v91
    v_smfmac_f32_32x32x32_bf16 a[240:255], a[178:181], v[116:123], v2
    v_exp_f32 v92, v92
    v_exp_f32 v93, v93
    v_exp_f32 v94, v94
    v_exp_f32 v95, v95
    v_smfmac_f32_32x32x32_bf16 a[240:255], a[182:185], v[124:131], v2
    global_load_dwordx4 a[178:181], v3, s[28:29] offset:1024 sc1
    v_exp_f32 v96, v96
    v_exp_f32 v97, v97
    v_exp_f32 v98, v98
    v_exp_f32 v99, v99
    v_mfma_f32_32x32x16_bf16 v[116:131], v[56:59], v[44:47], 0
    global_load_dwordx4 v[176:179], v1, s[52:53] offset:2048 sc1
    v_exp_f32 v100, v100
    v_exp_f32 v101, v101
    v_exp_f32 v102, v102
    v_exp_f32 v103, v103
    v_mfma_f32_32x32x8_bf16 v[116:131], v[68:69], v[48:49], v[116:131]
    v_exp_f32 v104, v104
    v_exp_f32 v105, v105
    v_exp_f32 v106, v106
    v_exp_f32 v107, v107
    v_smfmac_f32_32x32x32_bf16 a[192:207], v[60:63], v[84:91], v2
    s_waitcnt vmcnt(18)
    global_load_dwordx4 a[182:185], v3, s[28:29] offset:1792 sc1
    v_exp_f32 v108, v108
    v_exp_f32 v109, v109
    v_exp_f32 v110, v110
    v_exp_f32_e64 v111, v111
    v_smfmac_f32_32x32x32_bf16 a[192:207], v[64:67], v[92:99], v2
    s_add_u32 s28, s28, 8192
    s_addc_u32 s29, s29, 0
    v_exp_f32 v112, v112
    v_exp_f32 v113, v113
    v_exp_f32 v114, v114
    v_exp_f32_e64 v115, v115
    v_mfma_f32_32x32x16_bf16 v[84:99], v[56:59], v[50:53], 0
    global_load_dwordx4 a[112:115], v22, s[30:31] offset:0 sc1
    v_exp_f32 v116, v116
    v_exp_f32 v117, v117
    v_exp_f32 v118, v118
    v_exp_f32 v119, v119
    v_mfma_f32_32x32x8_bf16 v[84:99], v[68:69], v[54:55], v[84:99]
    v_exp_f32 v120, v120
    v_exp_f32 v121, v121
    v_exp_f32 v122, v122
    v_exp_f32 v123, v123
    v_smfmac_f32_32x32x32_bf16 a[208:223], v[60:63], v[100:107], v2
    global_load_dwordx4 v[56:59], v1, s[28:29] offset:-4096 sc1
    v_exp_f32 v124, v124
    v_exp_f32 v125, v125
    v_exp_f32 v126, v126
    v_exp_f32 v127, v127
    v_smfmac_f32_32x32x32_bf16 a[208:223], v[64:67], v[108:115], v2
    global_load_dwordx4 v[180:183], v1, s[52:53] offset:3072 sc1
    v_exp_f32 v128, v128
    v_exp_f32 v129, v129
    v_exp_f32 v130, v130
    v_exp_f32 v131, v131
    v_mfma_f32_32x32x16_bf16 v[100:115], v[70:73], v[32:35], 0
    v_exp_f32 v84, v84
    v_exp_f32 v85, v85
    v_exp_f32 v86, v86
    v_exp_f32 v87, v87
    v_mfma_f32_32x32x8_bf16 v[100:115], v[82:83], v[36:37], v[100:115]
    v_exp_f32 v88, v88
    v_exp_f32 v89, v89
    v_exp_f32 v90, v90
    v_exp_f32 v91, v91
    v_smfmac_f32_32x32x32_bf16 a[224:239], v[60:63], v[116:123], v2
    global_load_dwordx2 v[68:69], v4, s[28:29] offset:-1536 sc1
    v_exp_f32 v92, v92
    v_exp_f32 v93, v93
    v_exp_f32 v94, v94
    v_exp_f32 v95, v95
    v_smfmac_f32_32x32x32_bf16 a[224:239], v[64:67], v[124:131], v2
    s_add_u32 s52, s72, 48128
    s_addc_u32 s53, s73, 0
    v_exp_f32 v96, v96
    v_exp_f32 v97, v97
    v_exp_f32 v98, v98
    v_exp_f32_e64 v99, v99
    v_mfma_f32_32x32x16_bf16 v[116:131], v[70:73], v[38:41], 0
    global_load_dwordx4 v[184:187], v1, s[52:53] offset:-4096 sc1
    v_exp_f32 v100, v100
    v_exp_f32 v101, v101
    v_exp_f32 v102, v102
    v_exp_f32 v103, v103
    v_mfma_f32_32x32x8_bf16 v[116:131], v[82:83], v[42:43], v[116:131]
    v_exp_f32 v104, v104
    v_exp_f32 v105, v105
    v_exp_f32 v106, v106
    v_exp_f32 v107, v107
    v_smfmac_f32_32x32x32_bf16 a[240:255], v[60:63], v[84:91], v2
    global_load_dwordx4 a[116:119], v23, s[30:31] offset:0 sc1
    v_exp_f32 v108, v108
    v_exp_f32 v109, v109
    v_exp_f32 v110, v110
    v_exp_f32 v111, v111
    v_smfmac_f32_32x32x32_bf16 a[240:255], v[64:67], v[92:99], v2
    global_load_dwordx4 v[60:63], v3, s[28:29] offset:-3072 sc1
    v_exp_f32 v112, v112
    v_exp_f32 v113, v113
    v_exp_f32 v114, v114
    v_exp_f32 v115, v115
    v_mfma_f32_32x32x16_bf16 v[84:99], v[70:73], v[44:47], 0
    global_load_dwordx4 v[188:191], v1, s[52:53] offset:-3072 sc1
    v_exp_f32 v116, v116
    v_exp_f32 v117, v117
    v_exp_f32 v118, v118
    v_exp_f32 v119, v119
    v_mfma_f32_32x32x8_bf16 v[84:99], v[82:83], v[48:49], v[84:99]
    v_exp_f32 v120, v120
    v_exp_f32 v121, v121
    v_exp_f32 v122, v122
    v_exp_f32 v123, v123
    v_smfmac_f32_32x32x32_bf16 a[192:207], v[74:77], v[100:107], v2
    s_waitcnt vmcnt(19)
    global_load_dwordx4 v[64:67], v3, s[28:29] offset:-2304 sc1
    v_exp_f32 v124, v124
    v_exp_f32 v125, v125
    v_exp_f32 v126, v126
    v_exp_f32_e64 v127, v127
    v_smfmac_f32_32x32x32_bf16 a[192:207], v[78:81], v[108:115], v2
    global_load_dwordx4 a[120:123], v24, s[30:31] offset:0 sc1
    v_exp_f32 v128, v128
    v_exp_f32 v129, v129
    v_exp_f32 v130, v130
    v_exp_f32 v131, v131
    v_mfma_f32_32x32x16_bf16 v[100:115], v[70:73], v[50:53], 0
    global_load_dwordx4 v[192:195], v1, s[52:53] offset:-2048 sc1
    v_exp_f32 v84, v84
    v_exp_f32 v85, v85
    v_exp_f32 v86, v86
    v_exp_f32 v87, v87
    v_mfma_f32_32x32x8_bf16 v[100:115], v[82:83], v[54:55], v[100:115]
    v_exp_f32 v88, v88
    v_exp_f32 v89, v89
    v_exp_f32 v90, v90
    v_exp_f32 v91, v91
    v_smfmac_f32_32x32x32_bf16 a[208:223], v[74:77], v[116:123], v2
    global_load_dwordx4 v[70:73], v1, s[28:29] offset:0 sc1
    v_exp_f32 v92, v92
    v_exp_f32 v93, v93
    v_exp_f32 v94, v94
    v_exp_f32 v95, v95
    v_smfmac_f32_32x32x32_bf16 a[208:223], v[78:81], v[124:131], v2
    v_exp_f32 v96, v96
    v_exp_f32 v97, v97
    v_exp_f32 v98, v98
    v_exp_f32 v99, v99
    v_mfma_f32_32x32x16_bf16 v[116:131], a[160:163], v[32:35], 0
    global_load_dwordx4 v[196:199], v1, s[52:53] offset:-1024 sc1
    v_exp_f32 v100, v100
    v_exp_f32 v101, v101
    v_exp_f32 v102, v102
    v_exp_f32 v103, v103
    v_mfma_f32_32x32x8_bf16 v[116:131], a[172:173], v[36:37], v[116:131]
    v_exp_f32 v104, v104
    v_exp_f32 v105, v105
    v_exp_f32 v106, v106
    v_exp_f32 v107, v107
    v_smfmac_f32_32x32x32_bf16 a[224:239], v[74:77], v[84:91], v2
    global_load_dwordx2 v[82:83], v4, s[28:29] offset:2560 sc1
    v_exp_f32 v108, v108
    v_exp_f32 v109, v109
    v_exp_f32 v110, v110
    v_exp_f32 v111, v111
    v_smfmac_f32_32x32x32_bf16 a[224:239], v[78:81], v[92:99], v2
    global_load_dwordx4 a[124:127], v25, s[30:31] offset:0 sc1
    v_exp_f32 v112, v112
    v_exp_f32 v113, v113
    v_exp_f32 v114, v114
    v_exp_f32 v115, v115
    v_mfma_f32_32x32x16_bf16 v[84:99], a[160:163], v[38:41], 0
    v_exp_f32 v116, v116
    v_exp_f32 v117, v117
    v_exp_f32 v118, v118
    v_exp_f32 v119, v119
    v_mfma_f32_32x32x8_bf16 v[84:99], a[172:173], v[42:43], v[84:99]
    v_exp_f32 v120, v120
    v_exp_f32 v121, v121
    v_exp_f32 v122, v122
    v_exp_f32 v123, v123
    v_smfmac_f32_32x32x32_bf16 a[240:255], v[74:77], v[100:107], v2
    global_load_dwordx4 v[200:203], v1, s[52:53] offset:0 sc1
    v_exp_f32 v124, v124
    v_exp_f32 v125, v125
    v_exp_f32 v126, v126
    v_exp_f32 v127, v127
    v_smfmac_f32_32x32x32_bf16 a[240:255], v[78:81], v[108:115], v2
    global_load_dwordx4 v[74:77], v3, s[28:29] offset:1024 sc1
    v_exp_f32 v128, v128
    v_exp_f32 v129, v129
    v_exp_f32 v130, v130
    v_exp_f32 v131, v131
    v_mfma_f32_32x32x16_bf16 v[100:115], a[160:163], v[44:47], 0
    v_exp_f32 v84, v84
    v_exp_f32 v85, v85
    v_exp_f32 v86, v86
    v_exp_f32 v87, v87
    v_mfma_f32_32x32x8_bf16 v[100:115], a[172:173], v[48:49], v[100:115]
    v_exp_f32 v88, v88
    v_exp_f32 v89, v89
    v_exp_f32 v90, v90
    v_exp_f32 v91, v91
    v_smfmac_f32_32x32x32_bf16 a[192:207], a[164:167], v[116:123], v2
    s_waitcnt vmcnt(17)
    global_load_dwordx4 v[78:81], v3, s[28:29] offset:1792 sc1
    v_exp_f32 v92, v92
    v_exp_f32 v93, v93
    v_exp_f32 v94, v94
    v_exp_f32_e64 v95, v95
    v_smfmac_f32_32x32x32_bf16 a[192:207], a[168:171], v[124:131], v2
    s_add_u32 s28, s28, 8192
    s_addc_u32 s29, s29, 0
    v_exp_f32 v96, v96
    v_exp_f32 v97, v97
    v_exp_f32 v98, v98
    v_exp_f32_e64 v99, v99
    v_mfma_f32_32x32x16_bf16 v[116:131], a[160:163], v[50:53], 0
    global_load_dwordx4 v[204:207], v1, s[52:53] offset:1024 sc1
    v_exp_f32 v100, v100
    v_exp_f32 v101, v101
    v_exp_f32 v102, v102
    v_exp_f32 v103, v103
    v_mfma_f32_32x32x8_bf16 v[116:131], a[172:173], v[54:55], v[116:131]
    v_exp_f32 v104, v104
    v_exp_f32 v105, v105
    v_exp_f32 v106, v106
    v_exp_f32 v107, v107
    v_smfmac_f32_32x32x32_bf16 a[208:223], a[164:167], v[84:91], v2
    global_load_dwordx4 a[160:163], v1, s[28:29] offset:-4096 sc1
    v_exp_f32 v108, v108
    v_exp_f32 v109, v109
    v_exp_f32 v110, v110
    v_exp_f32 v111, v111
    v_smfmac_f32_32x32x32_bf16 a[208:223], a[168:171], v[92:99], v2
    s_add_u32 s30, s30, 8192
    s_addc_u32 s31, s31, 0
    v_exp_f32 v112, v112
    v_exp_f32 v113, v113
    v_exp_f32 v114, v114
    v_exp_f32_e64 v115, v115
    v_mfma_f32_32x32x16_bf16 v[84:99], a[174:177], v[32:35], 0
    global_load_dwordx4 a[128:131], v22, s[30:31] offset:-4096 sc1
    v_exp_f32 v116, v116
    v_exp_f32 v117, v117
    v_exp_f32 v118, v118
    v_exp_f32 v119, v119
    v_mfma_f32_32x32x8_bf16 v[84:99], a[186:187], v[36:37], v[84:99]
    v_exp_f32 v120, v120
    v_exp_f32 v121, v121
    v_exp_f32 v122, v122
    v_exp_f32 v123, v123
    v_smfmac_f32_32x32x32_bf16 a[224:239], a[164:167], v[100:107], v2
    global_load_dwordx2 a[172:173], v4, s[28:29] offset:-1536 sc1
    v_exp_f32 v124, v124
    v_exp_f32 v125, v125
    v_exp_f32 v126, v126
    v_exp_f32 v127, v127
    v_smfmac_f32_32x32x32_bf16 a[224:239], a[168:171], v[108:115], v2
    global_load_dwordx4 v[208:211], v1, s[52:53] offset:2048 sc1
    v_exp_f32 v128, v128
    v_exp_f32 v129, v129
    v_exp_f32 v130, v130
    v_exp_f32 v131, v131
    v_mfma_f32_32x32x16_bf16 v[100:115], a[174:177], v[38:41], 0
    global_load_dwordx4 a[132:135], v23, s[30:31] offset:-4096 sc1
    v_exp_f32 v84, v84
    v_exp_f32 v85, v85
    v_exp_f32 v86, v86
    v_exp_f32 v87, v87
    v_mfma_f32_32x32x8_bf16 v[100:115], a[186:187], v[42:43], v[100:115]
    v_exp_f32 v88, v88
    v_exp_f32 v89, v89
    v_exp_f32 v90, v90
    v_exp_f32 v91, v91
    v_smfmac_f32_32x32x32_bf16 a[240:255], a[164:167], v[116:123], v2
    global_load_dwordx4 v[212:215], v1, s[52:53] offset:3072 sc1
    v_exp_f32 v92, v92
    v_exp_f32 v93, v93
    v_exp_f32 v94, v94
    v_exp_f32 v95, v95
    v_smfmac_f32_32x32x32_bf16 a[240:255], a[168:171], v[124:131], v2
    global_load_dwordx4 a[164:167], v3, s[28:29] offset:-3072 sc1
    v_exp_f32 v96, v96
    v_exp_f32 v97, v97
    v_exp_f32 v98, v98
    v_exp_f32 v99, v99
    v_mfma_f32_32x32x16_bf16 v[116:131], a[174:177], v[44:47], 0
    global_load_dwordx4 a[136:139], v24, s[30:31] offset:-4096 sc1
    v_exp_f32 v100, v100
    v_exp_f32 v101, v101
    v_exp_f32 v102, v102
    v_exp_f32 v103, v103
    v_mfma_f32_32x32x8_bf16 v[116:131], a[186:187], v[48:49], v[116:131]
    v_exp_f32 v104, v104
    v_exp_f32 v105, v105
    v_exp_f32 v106, v106
    v_exp_f32 v107, v107
    v_smfmac_f32_32x32x32_bf16 a[192:207], a[178:181], v[84:91], v2
    s_waitcnt vmcnt(18)
    global_load_dwordx4 a[168:171], v3, s[28:29] offset:-2304 sc1
    v_exp_f32 v108, v108
    v_exp_f32 v109, v109
    v_exp_f32 v110, v110
    v_exp_f32_e64 v111, v111
    v_smfmac_f32_32x32x32_bf16 a[192:207], a[182:185], v[92:99], v2
    s_add_u32 s52, s72, 56320
    s_addc_u32 s53, s73, 0
    v_exp_f32 v112, v112
    v_exp_f32 v113, v113
    v_exp_f32 v114, v114
    v_exp_f32_e64 v115, v115
    v_mfma_f32_32x32x16_bf16 v[84:99], a[174:177], v[50:53], 0
    global_load_dwordx4 v[216:219], v1, s[52:53] offset:-4096 sc1
    v_exp_f32 v116, v116
    v_exp_f32 v117, v117
    v_exp_f32 v118, v118
    v_exp_f32 v119, v119
    v_mfma_f32_32x32x8_bf16 v[84:99], a[186:187], v[54:55], v[84:99]
    v_exp_f32 v120, v120
    v_exp_f32 v121, v121
    v_exp_f32 v122, v122
    v_exp_f32 v123, v123
    v_smfmac_f32_32x32x32_bf16 a[208:223], a[178:181], v[100:107], v2
    global_load_dwordx4 a[174:177], v1, s[28:29] offset:0 sc1
    v_exp_f32 v124, v124
    v_exp_f32 v125, v125
    v_exp_f32 v126, v126
    v_exp_f32 v127, v127
    v_smfmac_f32_32x32x32_bf16 a[208:223], a[182:185], v[108:115], v2
    global_load_dwordx4 v[220:223], v1, s[52:53] offset:-3072 sc1
    v_exp_f32 v128, v128
    v_exp_f32 v129, v129
    v_exp_f32 v130, v130
    v_exp_f32 v131, v131
    v_mfma_f32_32x32x16_bf16 v[100:115], v[56:59], v[32:35], 0
    global_load_dwordx4 a[140:143], v25, s[30:31] offset:-4096 sc1
    v_exp_f32 v84, v84
    v_exp_f32 v85, v85
    v_exp_f32 v86, v86
    v_exp_f32 v87, v87
    v_mfma_f32_32x32x8_bf16 v[100:115], v[68:69], v[36:37], v[100:115]
    v_exp_f32 v88, v88
    v_exp_f32 v89, v89
    v_exp_f32 v90, v90
    v_exp_f32 v91, v91
    v_smfmac_f32_32x32x32_bf16 a[224:239], a[178:181], v[116:123], v2
    global_load_dwordx2 a[186:187], v4, s[28:29] offset:2560 sc1
    v_exp_f32 v92, v92
    v_exp_f32 v93, v93
    v_exp_f32 v94, v94
    v_exp_f32 v95, v95
    v_smfmac_f32_32x32x32_bf16 a[224:239], a[182:185], v[124:131], v2
    global_load_dwordx4 v[224:227], v1, s[52:53] offset:-2048 sc1
    v_exp_f32 v96, v96
    v_exp_f32 v97, v97
    v_exp_f32 v98, v98
    v_exp_f32 v99, v99
    v_mfma_f32_32x32x16_bf16 v[116:131], v[56:59], v[38:41], 0
    v_exp_f32 v100, v100
    v_exp_f32 v101, v101
    v_exp_f32 v102, v102
    v_exp_f32 v103, v103
    v_mfma_f32_32x32x8_bf16 v[116:131], v[68:69], v[42:43], v[116:131]
    v_exp_f32 v104, v104
    v_exp_f32 v105, v105
    v_exp_f32 v106, v106
    v_exp_f32 v107, v107
    v_smfmac_f32_32x32x32_bf16 a[240:255], a[178:181], v[84:91], v2
    v_exp_f32 v108, v108
    v_exp_f32 v109, v109
    v_exp_f32 v110, v110
    v_exp_f32 v111, v111
    v_smfmac_f32_32x32x32_bf16 a[240:255], a[182:185], v[92:99], v2
    global_load_dwordx4 a[178:181], v3, s[28:29] offset:1024 sc1
    v_exp_f32 v112, v112
    v_exp_f32 v113, v113
    v_exp_f32 v114, v114
    v_exp_f32 v115, v115
    v_mfma_f32_32x32x16_bf16 v[84:99], v[56:59], v[44:47], 0
    global_load_dwordx4 a[144:147], v22, s[30:31] offset:0 sc1
    v_exp_f32 v116, v116
    v_exp_f32 v117, v117
    v_exp_f32 v118, v118
    v_exp_f32 v119, v119
    v_mfma_f32_32x32x8_bf16 v[84:99], v[68:69], v[48:49], v[84:99]
    v_exp_f32 v120, v120
    v_exp_f32 v121, v121
    v_exp_f32 v122, v122
    v_exp_f32 v123, v123
    v_smfmac_f32_32x32x32_bf16 a[192:207], v[60:63], v[100:107], v2
    s_waitcnt vmcnt(18)
    global_load_dwordx4 a[182:185], v3, s[28:29] offset:1792 sc1
    v_exp_f32 v124, v124
    v_exp_f32 v125, v125
    v_exp_f32 v126, v126
    v_exp_f32_e64 v127, v127
    v_smfmac_f32_32x32x32_bf16 a[192:207], v[64:67], v[108:115], v2
    s_add_u32 s28, s28, 8192
    s_addc_u32 s29, s29, 0
    v_exp_f32 v128, v128
    v_exp_f32 v129, v129
    v_exp_f32 v130, v130
    v_exp_f32_e64 v131, v131
    v_mfma_f32_32x32x16_bf16 v[100:115], v[56:59], v[50:53], 0
    global_load_dwordx4 v[228:231], v1, s[52:53] offset:-1024 sc1
    v_exp_f32 v84, v84
    v_exp_f32 v85, v85
    v_exp_f32 v86, v86
    v_exp_f32 v87, v87
    v_mfma_f32_32x32x8_bf16 v[100:115], v[68:69], v[54:55], v[100:115]
    v_exp_f32 v88, v88
    v_exp_f32 v89, v89
    v_exp_f32 v90, v90
    v_exp_f32 v91, v91
    v_smfmac_f32_32x32x32_bf16 a[208:223], v[60:63], v[116:123], v2
    global_load_dwordx4 v[232:235], v1, s[52:53] offset:0 sc1
    v_exp_f32 v92, v92
    v_exp_f32 v93, v93
    v_exp_f32 v94, v94
    v_exp_f32 v95, v95
    v_smfmac_f32_32x32x32_bf16 a[208:223], v[64:67], v[124:131], v2
    global_load_dwordx4 a[148:151], v23, s[30:31] offset:0 sc1
    v_exp_f32 v96, v96
    v_exp_f32 v97, v97
    v_exp_f32 v98, v98
    v_exp_f32 v99, v99
    v_mfma_f32_32x32x16_bf16 v[116:131], v[70:73], v[32:35], 0
    v_exp_f32 v100, v100
    v_exp_f32 v101, v101
    v_exp_f32 v102, v102
    v_exp_f32 v103, v103
    v_mfma_f32_32x32x8_bf16 v[116:131], v[82:83], v[36:37], v[116:131]
    v_exp_f32 v104, v104
    v_exp_f32 v105, v105
    v_exp_f32 v106, v106
    v_exp_f32 v107, v107
    v_smfmac_f32_32x32x32_bf16 a[224:239], v[60:63], v[84:91], v2
    global_load_dwordx4 v[236:239], v1, s[52:53] offset:1024 sc1
    v_exp_f32 v108, v108
    v_exp_f32 v109, v109
    v_exp_f32 v110, v110
    v_exp_f32 v111, v111
    v_smfmac_f32_32x32x32_bf16 a[224:239], v[64:67], v[92:99], v2
    v_exp_f32 v112, v112
    v_exp_f32 v113, v113
    v_exp_f32 v114, v114
    v_exp_f32 v115, v115
    v_mfma_f32_32x32x16_bf16 v[84:99], v[70:73], v[38:41], 0
    v_exp_f32 v116, v116
    v_exp_f32 v117, v117
    v_exp_f32 v118, v118
    v_exp_f32 v119, v119
    v_mfma_f32_32x32x8_bf16 v[84:99], v[82:83], v[42:43], v[84:99]
    v_exp_f32 v120, v120
    v_exp_f32 v121, v121
    v_exp_f32 v122, v122
    v_exp_f32 v123, v123
    v_smfmac_f32_32x32x32_bf16 a[240:255], v[60:63], v[100:107], v2
    global_load_dwordx4 a[152:155], v24, s[30:31] offset:0 sc1
    v_exp_f32 v124, v124
    v_exp_f32 v125, v125
    v_exp_f32 v126, v126
    v_exp_f32 v127, v127
    v_smfmac_f32_32x32x32_bf16 a[240:255], v[64:67], v[108:115], v2
    global_load_dwordx4 v[240:243], v1, s[52:53] offset:2048 sc1
    v_exp_f32 v128, v128
    v_exp_f32 v129, v129
    v_exp_f32 v130, v130
    v_exp_f32 v131, v131
    v_mfma_f32_32x32x16_bf16 v[100:115], v[70:73], v[44:47], 0
    v_exp_f32 v84, v84
    v_exp_f32 v85, v85
    v_exp_f32 v86, v86
    v_exp_f32 v87, v87
    v_mfma_f32_32x32x8_bf16 v[100:115], v[82:83], v[48:49], v[100:115]
    v_exp_f32 v88, v88
    v_exp_f32 v89, v89
    v_exp_f32 v90, v90
    v_exp_f32 v91, v91
    v_smfmac_f32_32x32x32_bf16 a[192:207], v[74:77], v[116:123], v2
    s_waitcnt vmcnt(15)
    v_exp_f32 v92, v92
    v_exp_f32 v93, v93
    v_exp_f32 v94, v94
    v_exp_f32_e64 v95, v95
    v_smfmac_f32_32x32x32_bf16 a[192:207], v[78:81], v[124:131], v2
    v_exp_f32 v96, v96
    v_exp_f32 v97, v97
    v_exp_f32 v98, v98
    v_exp_f32 v99, v99
    v_mfma_f32_32x32x16_bf16 v[116:131], v[70:73], v[50:53], 0
    global_load_dwordx4 v[244:247], v1, s[52:53] offset:3072 sc1
    v_exp_f32 v100, v100
    v_exp_f32 v101, v101
    v_exp_f32 v102, v102
    v_exp_f32 v103, v103
    v_mfma_f32_32x32x8_bf16 v[116:131], v[82:83], v[54:55], v[116:131]
    v_exp_f32 v104, v104
    v_exp_f32 v105, v105
    v_exp_f32 v106, v106
    v_exp_f32 v107, v107
    v_smfmac_f32_32x32x32_bf16 a[208:223], v[74:77], v[84:91], v2
    global_load_dwordx4 a[156:159], v25, s[30:31] offset:0 sc1
    v_exp_f32 v108, v108
    v_exp_f32 v109, v109
    v_exp_f32 v110, v110
    v_exp_f32 v111, v111
    v_smfmac_f32_32x32x32_bf16 a[208:223], v[78:81], v[92:99], v2
    v_exp_f32 v112, v112
    v_exp_f32 v113, v113
    v_exp_f32 v114, v114
    v_exp_f32 v115, v115
    v_mfma_f32_32x32x16_bf16 v[84:99], a[160:163], v[32:35], 0
    v_exp_f32 v116, v116
    v_exp_f32 v117, v117
    v_exp_f32 v118, v118
    v_exp_f32 v119, v119
    v_mfma_f32_32x32x8_bf16 v[84:99], a[172:173], v[36:37], v[84:99]
    v_exp_f32 v120, v120
    v_exp_f32 v121, v121
    v_exp_f32 v122, v122
    v_exp_f32 v123, v123
    v_smfmac_f32_32x32x32_bf16 a[224:239], v[74:77], v[100:107], v2
    s_add_u32 s52, s72, 64512
    s_addc_u32 s53, s73, 0
    v_exp_f32 v124, v124
    v_exp_f32 v125, v125
    v_exp_f32 v126, v126
    v_exp_f32_e64 v127, v127
    v_smfmac_f32_32x32x32_bf16 a[224:239], v[78:81], v[108:115], v2
    global_load_dwordx4 v[248:251], v1, s[52:53] offset:-4096 sc1
    v_exp_f32 v128, v128
    v_exp_f32 v129, v129
    v_exp_f32 v130, v130
    v_exp_f32 v131, v131
    v_mfma_f32_32x32x16_bf16 v[100:115], a[160:163], v[38:41], 0
    v_exp_f32 v84, v84
    v_exp_f32 v85, v85
    v_exp_f32 v86, v86
    v_exp_f32 v87, v87
    v_mfma_f32_32x32x8_bf16 v[100:115], a[172:173], v[42:43], v[100:115]
    v_exp_f32 v88, v88
    v_exp_f32 v89, v89
    v_exp_f32 v90, v90
    v_exp_f32 v91, v91
    v_smfmac_f32_32x32x32_bf16 a[240:255], v[74:77], v[116:123], v2
    s_add_u32 s30, s30, 8192
    s_addc_u32 s31, s31, 0
    v_exp_f32 v92, v92
    v_exp_f32 v93, v93
    v_exp_f32 v94, v94
    v_exp_f32_e64 v95, v95
    v_smfmac_f32_32x32x32_bf16 a[240:255], v[78:81], v[124:131], v2
    v_exp_f32 v96, v96
    v_exp_f32 v97, v97
    v_exp_f32 v98, v98
    v_exp_f32 v99, v99
    v_mfma_f32_32x32x16_bf16 v[116:131], a[160:163], v[44:47], 0
    v_exp_f32 v100, v100
    v_exp_f32 v101, v101
    v_exp_f32 v102, v102
    v_exp_f32 v103, v103
    v_mfma_f32_32x32x8_bf16 v[116:131], a[172:173], v[48:49], v[116:131]
    v_exp_f32 v104, v104
    v_exp_f32 v105, v105
    v_exp_f32 v106, v106
    v_exp_f32 v107, v107
    v_smfmac_f32_32x32x32_bf16 a[192:207], a[164:167], v[84:91], v2
    s_waitcnt vmcnt(9)
    v_exp_f32 v108, v108
    v_exp_f32 v109, v109
    v_exp_f32 v110, v110
    v_exp_f32_e64 v111, v111
    v_smfmac_f32_32x32x32_bf16 a[192:207], a[168:171], v[92:99], v2
    v_exp_f32 v112, v112
    v_exp_f32 v113, v113
    v_exp_f32 v114, v114
    v_exp_f32 v115, v115
    v_mfma_f32_32x32x16_bf16 v[84:99], a[160:163], v[50:53], 0
    v_exp_f32 v116, v116
    v_exp_f32 v117, v117
    v_exp_f32 v118, v118
    v_exp_f32 v119, v119
    v_mfma_f32_32x32x8_bf16 v[84:99], a[172:173], v[54:55], v[84:99]
    v_exp_f32 v120, v120
    v_exp_f32 v121, v121
    v_exp_f32 v122, v122
    v_exp_f32 v123, v123
    v_smfmac_f32_32x32x32_bf16 a[208:223], a[164:167], v[100:107], v2
    v_exp_f32 v124, v124
    v_exp_f32 v125, v125
    v_exp_f32 v126, v126
    v_exp_f32 v127, v127
    v_smfmac_f32_32x32x32_bf16 a[208:223], a[168:171], v[108:115], v2
    v_exp_f32 v128, v128
    v_exp_f32 v129, v129
    v_exp_f32 v130, v130
    v_exp_f32 v131, v131
    v_mfma_f32_32x32x16_bf16 v[100:115], a[174:177], v[44:47], 0
    v_exp_f32 v84, v84
    v_exp_f32 v85, v85
    v_exp_f32 v86, v86
    v_exp_f32 v87, v87
    v_mfma_f32_32x32x8_bf16 v[100:115], a[186:187], v[48:49], v[100:115]
    v_exp_f32 v88, v88
    v_exp_f32 v89, v89
    v_exp_f32 v90, v90
    v_exp_f32 v91, v91
    v_smfmac_f32_32x32x32_bf16 a[224:239], a[164:167], v[116:123], v2
    v_exp_f32 v92, v92
    v_exp_f32 v93, v93
    v_exp_f32 v94, v94
    v_exp_f32 v95, v95
    v_smfmac_f32_32x32x32_bf16 a[224:239], a[168:171], v[124:131], v2
    v_exp_f32 v96, v96
    v_exp_f32 v97, v97
    v_exp_f32 v98, v98
    v_exp_f32 v99, v99
    v_mfma_f32_32x32x16_bf16 v[116:131], a[174:177], v[50:53], 0
    v_exp_f32 v100, v100
    v_exp_f32 v101, v101
    v_exp_f32 v102, v102
    v_exp_f32 v103, v103
    v_mfma_f32_32x32x8_bf16 v[116:131], a[186:187], v[54:55], v[116:131]
    v_exp_f32 v104, v104
    v_exp_f32 v105, v105
    v_exp_f32 v106, v106
    v_exp_f32 v107, v107
    v_smfmac_f32_32x32x32_bf16 a[240:255], a[164:167], v[84:91], v2
    v_exp_f32 v108, v108
    v_exp_f32 v109, v109
    v_exp_f32 v110, v110
    v_exp_f32 v111, v111
    v_smfmac_f32_32x32x32_bf16 a[240:255], a[168:171], v[92:99], v2
    v_exp_f32 v112, v112
    v_exp_f32 v113, v113
    v_exp_f32 v114, v114
    v_exp_f32 v115, v115
    v_mfma_f32_32x32x16_bf16 v[84:99], a[174:177], v[32:35], 0
    v_exp_f32 v116, v116
    v_exp_f32 v117, v117
    v_exp_f32 v118, v118
    v_exp_f32 v119, v119
    v_mfma_f32_32x32x8_bf16 v[84:99], a[186:187], v[36:37], v[84:99]
    v_exp_f32 v120, v120
    v_exp_f32 v121, v121
    v_exp_f32 v122, v122
    v_exp_f32 v123, v123
    v_smfmac_f32_32x32x32_bf16 a[224:239], a[178:181], v[100:107], v2
    v_exp_f32 v124, v124
    v_exp_f32 v125, v125
    v_exp_f32 v126, v126
    v_exp_f32 v127, v127
    v_smfmac_f32_32x32x32_bf16 a[224:239], a[182:185], v[108:115], v2
    v_exp_f32 v128, v128
    v_exp_f32 v129, v129
    v_exp_f32 v130, v130
    v_exp_f32 v131, v131
    v_mfma_f32_32x32x16_bf16 v[100:115], a[174:177], v[38:41], 0
    v_exp_f32 v84, v84
    v_exp_f32 v85, v85
    v_exp_f32 v86, v86
    v_exp_f32 v87, v87
    v_mfma_f32_32x32x8_bf16 v[100:115], a[186:187], v[42:43], v[100:115]
    v_exp_f32 v88, v88
    v_exp_f32 v89, v89
    v_exp_f32 v90, v90
    v_exp_f32 v91, v91
    v_smfmac_f32_32x32x32_bf16 a[240:255], a[178:181], v[116:123], v2
    ds_write_b128 v252, a[224:227] offset:0
    v_exp_f32 v92, v92
    v_exp_f32 v93, v93
    v_exp_f32 v94, v94
    v_exp_f32 v95, v95
    v_smfmac_f32_32x32x32_bf16 a[240:255], a[182:185], v[124:131], v2
    ds_write_b128 v252, a[228:231] offset:1024
    v_exp_f32 v96, v96
    v_exp_f32 v97, v97
    v_exp_f32 v98, v98
    v_exp_f32 v99, v99
    ds_write_b128 v252, a[232:235] offset:2048
    v_exp_f32 v100, v100
    v_exp_f32 v101, v101
    v_exp_f32 v102, v102
    v_exp_f32 v103, v103
    v_exp_f32 v104, v104
    v_exp_f32 v105, v105
    v_exp_f32 v106, v106
    v_exp_f32 v107, v107
    v_smfmac_f32_32x32x32_bf16 a[192:207], a[178:181], v[84:91], v2
    ds_write_b128 v252, a[240:243] offset:3072
    v_exp_f32 v108, v108
    v_exp_f32 v109, v109
    v_exp_f32 v110, v110
    v_exp_f32 v111, v111
    v_smfmac_f32_32x32x32_bf16 a[192:207], a[182:185], v[92:99], v2
    ds_write_b128 v252, a[244:247] offset:4096
    ds_write_b128 v252, a[248:251] offset:5120
    v_exp_f32 v112, v112
    v_exp_f32 v113, v113
    v_exp_f32 v114, v114
    v_exp_f32 v115, v115
    v_smfmac_f32_32x32x32_bf16 a[208:223], a[178:181], v[100:107], v2
    s_nop 0
    v_smfmac_f32_32x32x32_bf16 a[208:223], a[182:185], v[108:115], v2
L_combine:
    v_accvgpr_read_b32 v98, a232
    v_accvgpr_read_b32 v99, a248
    s_nop 0
    v_accvgpr_read_b32 v96, a200
    v_accvgpr_read_b32 v72, a192
    v_accvgpr_read_b32 v73, a193
    v_accvgpr_read_b32 v74, a194
    v_accvgpr_read_b32 v75, a195
    v_accvgpr_read_b32 v76, a196
    v_accvgpr_read_b32 v77, a197
    v_accvgpr_read_b32 v78, a198
    v_accvgpr_read_b32 v79, a199
    v_accvgpr_read_b32 v80, a200
    v_accvgpr_read_b32 v97, a216
    ds_write_b128 v253, v[96:99]
    v_accvgpr_read_b32 v81, a201
    v_accvgpr_read_b32 v82, a202
    v_accvgpr_read_b32 v83, a203
    v_accvgpr_read_b32 v84, a208
    v_accvgpr_read_b32 v85, a209
    v_accvgpr_read_b32 v86, a210
    v_accvgpr_read_b32 v87, a211
    v_accvgpr_read_b32 v88, a212
    v_accvgpr_read_b32 v89, a213
    v_accvgpr_read_b32 v90, a214
    v_accvgpr_read_b32 v91, a215
    v_accvgpr_read_b32 v92, a216
    v_accvgpr_read_b32 v93, a217
    v_accvgpr_read_b32 v94, a218
    v_accvgpr_read_b32 v95, a219
    s_waitcnt lgkmcnt(0)
    s_barrier
    ds_read_b128 v[96:99], v255
    ds_read_b128 v[100:103], v255 offset:2048
    ds_read_b128 v[116:119], v254 offset:2048
    ds_read_b128 v[128:131], v254 offset:5120
    ds_read_b128 v[108:111], v254 offset:0
    ds_read_b128 v[112:115], v254 offset:1024
    ds_read_b128 v[120:123], v254 offset:3072
    ds_read_b128 v[124:127], v254 offset:4096
    s_mov_b32 s59, 0x5d800000
    s_waitcnt lgkmcnt(6)
    v_add_f32 v96, v96, v102
    v_add_f32 v97, v97, v103
    v_add_f32 v98, v98, v100
    v_add_f32_e64 v99, v99, v101
    v_min3_f32 v100, v96, v97, v98
    v_add_f32 v96, v96, v97
    v_add_f32 v98, v98, v99
    v_min_f32 v100, v100, v99
    v_add_f32 v96, v96, v98
    v_cmp_nle_f32 vcc, 0x21800000, v100
    v_cmp_nge_f32 s[48:49], s59, v96
    s_waitcnt lgkmcnt(5)
    v_pk_add_f32 v[80:81], v[80:81], v[116:117]
    s_waitcnt lgkmcnt(4)
    v_pk_add_f32 v[92:93], v[92:93], v[128:129]
    s_or_b64 vcc, vcc, s[48:49]
    s_cmp_eq_u32 s82, 0
    s_cselect_b64 vcc, vcc, 0
    s_cbranch_vccnz L_fallback
    v_mov_b32 v96, v80
    v_mov_b32 v97, v92
    v_pk_add_f32 v[82:83], v[82:83], v[118:119]
    v_pk_add_f32 v[94:95], v[94:95], v[130:131]
    v_permlane32_swap_b32 v80, v96
    v_permlane32_swap_b32 v92, v97
    v_rcp_f32 v100, v96
    v_rcp_f32_e64 v102, v97
    s_waitcnt lgkmcnt(3)
    v_pk_add_f32 v[72:73], v[72:73], v[108:109]
    v_pk_add_f32 v[74:75], v[74:75], v[110:111]
    s_waitcnt lgkmcnt(2)
    v_pk_add_f32 v[76:77], v[76:77], v[112:113]
    v_pk_add_f32 v[78:79], v[78:79], v[114:115]
    s_waitcnt lgkmcnt(1)
    v_pk_add_f32 v[84:85], v[84:85], v[120:121]
    v_pk_add_f32 v[86:87], v[86:87], v[122:123]
    s_waitcnt lgkmcnt(0)
    v_pk_add_f32 v[88:89], v[88:89], v[124:125]
    v_pk_add_f32 v[90:91], v[90:91], v[126:127]
    v_mul_f32 v100, v16, v100
    v_mul_f32_e64 v102, v16, v102
    v_pk_mul_f32 v[72:73], v[72:73], v[100:101] op_sel_hi:[1,0]
    v_pk_mul_f32 v[74:75], v[74:75], v[100:101] op_sel_hi:[1,0]
    v_pk_mul_f32 v[76:77], v[76:77], v[100:101] op_sel_hi:[1,0]
    v_pk_mul_f32 v[78:79], v[78:79], v[100:101] op_sel_hi:[1,0]
    v_pk_mul_f32 v[80:81], v[80:81], v[100:101] op_sel_hi:[1,0]
    v_pk_mul_f32 v[82:83], v[82:83], v[100:101] op_sel_hi:[1,0]
    v_pk_mul_f32 v[84:85], v[84:85], v[102:103] op_sel_hi:[1,0]
    v_pk_mul_f32 v[86:87], v[86:87], v[102:103] op_sel_hi:[1,0]
    v_pk_mul_f32 v[88:89], v[88:89], v[102:103] op_sel_hi:[1,0]
    v_pk_mul_f32 v[90:91], v[90:91], v[102:103] op_sel_hi:[1,0]
    v_pk_mul_f32 v[92:93], v[92:93], v[102:103] op_sel_hi:[1,0]
    v_pk_mul_f32 v[94:95], v[94:95], v[102:103] op_sel_hi:[1,0]
    v_cvt_pk_bf16_f32 v122, v76, v77
    v_cvt_pk_bf16_f32 v126, v84, v85
    v_cvt_pk_bf16_f32 v123, v78, v79
    v_cvt_pk_bf16_f32 v127, v86, v87
    v_cvt_pk_bf16_f32 v120, v72, v73
    v_cvt_pk_bf16_f32 v121, v74, v75
    v_permlane32_swap_b32 v122, v126
    v_permlane32_swap_b32 v123, v127
    buffer_store_dwordx4 v[120:123], v19, s[40:43], s75 offen sc1
    v_cvt_pk_bf16_f32 v124, v80, v81
    v_cvt_pk_bf16_f32 v125, v82, v83
    buffer_store_dwordx4 v[124:127], v20, s[40:43], s75 offen sc1
    v_cvt_pk_bf16_f32 v128, v88, v89
    v_cvt_pk_bf16_f32 v129, v90, v91
    v_cvt_pk_bf16_f32 v130, v92, v93
    v_cvt_pk_bf16_f32 v131, v94, v95
    v_cndmask_b32 v130, v130, v126, s[80:81]
    v_cndmask_b32 v131, v131, v127, s[80:81]
    buffer_store_dwordx4 v[128:131], v21, s[40:43], s75 offen sc1
    v_mfma_f32_16x16x32_bf16 v[32:35], v[132:135], a[0:3], 0
    global_load_dwordx4 a[192:195], v22, s[30:31] offset:-4096 sc1
    v_mfma_f32_16x16x32_bf16 v[36:39], v[136:139], a[0:3], 0
    global_load_dwordx4 a[196:199], v23, s[30:31] offset:-4096 sc1
    v_mfma_f32_16x16x32_bf16 v[40:43], v[140:143], a[0:3], 0
    ds_read_b128 v[112:115], v15 offset:0
    global_load_dwordx4 a[200:203], v24, s[30:31] offset:-4096 sc1
    v_mfma_f32_16x16x32_bf16 v[44:47], v[144:147], a[0:3], 0
    v_mfma_f32_16x16x32_bf16 v[48:51], v[148:151], a[0:3], 0
    ds_read_b128 v[116:119], v15 offset:1024
    v_mfma_f32_16x16x32_bf16 v[52:55], v[132:135], a[4:7], 0
    v_mfma_f32_16x16x32_bf16 v[56:59], v[136:139], a[4:7], 0
    ds_read_b128 v[120:123], v15 offset:2048
    v_mfma_f32_16x16x32_bf16 v[60:63], v[140:143], a[4:7], 0
    v_mfma_f32_16x16x32_bf16 v[64:67], v[144:147], a[4:7], 0
    ds_read_b128 v[124:127], v15 offset:3072
    global_load_dwordx4 a[204:207], v25, s[30:31] offset:-4096 sc1
    v_mfma_f32_16x16x32_bf16 v[68:71], v[148:151], a[4:7], 0
    v_mfma_f32_16x16x32_bf16 v[72:75], v[132:135], a[8:11], 0
    ds_read_b128 v[128:131], v15 offset:4096
    v_mfma_f32_16x16x32_bf16 v[76:79], v[136:139], a[8:11], 0
    v_mfma_f32_16x16x32_bf16 v[80:83], v[140:143], a[8:11], 0
    v_mfma_f32_16x16x32_bf16 v[84:87], v[144:147], a[8:11], 0
    v_mfma_f32_16x16x32_bf16 v[88:91], v[148:151], a[8:11], 0
    global_load_dwordx4 a[208:211], v22, s[30:31] offset:0 sc1
    v_mfma_f32_16x16x32_bf16 v[92:95], v[132:135], a[12:15], 0
    v_mfma_f32_16x16x32_bf16 v[96:99], v[136:139], a[12:15], 0
    v_mfma_f32_16x16x32_bf16 v[100:103], v[140:143], a[12:15], 0
    v_mfma_f32_16x16x32_bf16 v[104:107], v[144:147], a[12:15], 0
    v_mfma_f32_16x16x32_bf16 v[108:111], v[148:151], a[12:15], 0
    s_waitcnt lgkmcnt(4)
    v_mfma_f32_16x16x32_bf16 v[32:35], v[112:115], a[16:19], v[32:35]
    s_waitcnt lgkmcnt(3)
    v_mfma_f32_16x16x32_bf16 v[36:39], v[116:119], a[16:19], v[36:39]
    s_lshl_b32 s59, s46, 2
    global_load_dwordx4 a[212:215], v23, s[30:31] offset:0 sc1
    s_waitcnt lgkmcnt(2)
    v_mfma_f32_16x16x32_bf16 v[40:43], v[120:123], a[16:19], v[40:43]
    ds_read_b128 v[132:135], v15 offset:5120
    s_waitcnt lgkmcnt(2)
    v_mfma_f32_16x16x32_bf16 v[44:47], v[124:127], a[16:19], v[44:47]
    s_add_u32 s59, s59, s77
    s_waitcnt lgkmcnt(1)
    v_mfma_f32_16x16x32_bf16 v[48:51], v[128:131], a[16:19], v[48:51]
    ds_read_b128 v[136:139], v15 offset:6144
    v_mfma_f32_16x16x32_bf16 v[52:55], v[112:115], a[20:23], v[52:55]
    v_and_b32 v27, 7, v28
    v_mfma_f32_16x16x32_bf16 v[56:59], v[116:119], a[20:23], v[56:59]
    ds_read_b128 v[140:143], v15 offset:7168
    v_mfma_f32_16x16x32_bf16 v[60:63], v[120:123], a[20:23], v[60:63]
    v_lshlrev_b32_e64 v27, 2, v27
    global_load_dwordx4 a[216:219], v24, s[30:31] offset:0 sc1
    v_mfma_f32_16x16x32_bf16 v[64:67], v[124:127], a[20:23], v[64:67]
    ds_read_b128 v[144:147], v15 offset:8192
    v_mfma_f32_16x16x32_bf16 v[68:71], v[128:131], a[20:23], v[68:71]
    s_mul_i32 s60, s44, 20480
    v_mfma_f32_16x16x32_bf16 v[72:75], v[112:115], a[24:27], v[72:75]
    ds_read_b128 v[148:151], v15 offset:9216
    v_mfma_f32_16x16x32_bf16 v[76:79], v[116:119], a[24:27], v[76:79]
    s_add_u32 s60, s60, s75
    v_mfma_f32_16x16x32_bf16 v[80:83], v[120:123], a[24:27], v[80:83]
    v_mfma_f32_16x16x32_bf16 v[84:87], v[124:127], a[24:27], v[84:87]
    s_add_u32 s61, s60, 4096
    v_mfma_f32_16x16x32_bf16 v[88:91], v[128:131], a[24:27], v[88:91]
    global_load_dwordx4 a[220:223], v25, s[30:31] offset:0 sc1
    v_mfma_f32_16x16x32_bf16 v[92:95], v[112:115], a[28:31], v[92:95]
    s_add_u32 s62, s60, 8192
    v_mfma_f32_16x16x32_bf16 v[96:99], v[116:119], a[28:31], v[96:99]
    v_mfma_f32_16x16x32_bf16 v[100:103], v[120:123], a[28:31], v[100:103]
    s_add_u32 s63, s60, 12288
    v_mfma_f32_16x16x32_bf16 v[104:107], v[124:127], a[28:31], v[104:107]
    v_mfma_f32_16x16x32_bf16 v[108:111], v[128:131], a[28:31], v[108:111]
    s_add_u32 s68, s60, 16384
    s_waitcnt lgkmcnt(4)
    v_mfma_f32_16x16x32_bf16 v[32:35], v[132:135], a[32:35], v[32:35]
    s_mul_i32 s58, s44, 35840
    s_sub_u32 s58, 249856, s58
    s_add_u32 s52, s72, s58
    s_addc_u32 s53, s73, 0
    global_load_dwordx4 a[160:163], v1, s[52:53] offset:-4096 sc1
    s_waitcnt lgkmcnt(3)
    v_mfma_f32_16x16x32_bf16 v[36:39], v[136:139], a[32:35], v[36:39]
    s_waitcnt lgkmcnt(2)
    v_mfma_f32_16x16x32_bf16 v[40:43], v[140:143], a[32:35], v[40:43]
    ds_read_b128 v[112:115], v15 offset:10240
    s_waitcnt lgkmcnt(2)
    v_mfma_f32_16x16x32_bf16 v[44:47], v[144:147], a[32:35], v[44:47]
    s_waitcnt lgkmcnt(1)
    v_mfma_f32_16x16x32_bf16 v[48:51], v[148:151], a[32:35], v[48:51]
    ds_read_b128 v[116:119], v15 offset:11264
    v_mfma_f32_16x16x32_bf16 v[52:55], v[132:135], a[36:39], v[52:55]
    v_mfma_f32_16x16x32_bf16 v[56:59], v[136:139], a[36:39], v[56:59]
    ds_read_b128 v[120:123], v15 offset:12288
    v_mfma_f32_16x16x32_bf16 v[60:63], v[140:143], a[36:39], v[60:63]
    global_load_dwordx4 a[164:167], v1, s[52:53] offset:-3072 sc1
    v_mfma_f32_16x16x32_bf16 v[64:67], v[144:147], a[36:39], v[64:67]
    ds_read_b128 v[124:127], v15 offset:13312
    v_mfma_f32_16x16x32_bf16 v[68:71], v[148:151], a[36:39], v[68:71]
    v_mfma_f32_16x16x32_bf16 v[72:75], v[132:135], a[40:43], v[72:75]
    ds_read_b128 v[128:131], v15 offset:14336
    v_mfma_f32_16x16x32_bf16 v[76:79], v[136:139], a[40:43], v[76:79]
    v_mfma_f32_16x16x32_bf16 v[80:83], v[140:143], a[40:43], v[80:83]
    v_mfma_f32_16x16x32_bf16 v[84:87], v[144:147], a[40:43], v[84:87]
    v_mfma_f32_16x16x32_bf16 v[88:91], v[148:151], a[40:43], v[88:91]
    global_load_dwordx4 a[168:171], v1, s[52:53] offset:-2048 sc1
    v_mfma_f32_16x16x32_bf16 v[92:95], v[132:135], a[44:47], v[92:95]
    v_mfma_f32_16x16x32_bf16 v[96:99], v[136:139], a[44:47], v[96:99]
    v_mfma_f32_16x16x32_bf16 v[100:103], v[140:143], a[44:47], v[100:103]
    v_mfma_f32_16x16x32_bf16 v[104:107], v[144:147], a[44:47], v[104:107]
    v_mfma_f32_16x16x32_bf16 v[108:111], v[148:151], a[44:47], v[108:111]
    s_waitcnt lgkmcnt(4)
    v_mfma_f32_16x16x32_bf16 v[32:35], v[112:115], a[48:51], v[32:35]
    global_load_dwordx4 a[172:175], v1, s[52:53] offset:-1024 sc1
    s_waitcnt lgkmcnt(3)
    v_mfma_f32_16x16x32_bf16 v[36:39], v[116:119], a[48:51], v[36:39]
    s_waitcnt lgkmcnt(2)
    v_mfma_f32_16x16x32_bf16 v[40:43], v[120:123], a[48:51], v[40:43]
    ds_read_b128 v[132:135], v15 offset:15360
    s_waitcnt lgkmcnt(2)
    v_mfma_f32_16x16x32_bf16 v[44:47], v[124:127], a[48:51], v[44:47]
    s_waitcnt lgkmcnt(1)
    v_mfma_f32_16x16x32_bf16 v[48:51], v[128:131], a[48:51], v[48:51]
    ds_read_b128 v[136:139], v15 offset:16384
    v_mfma_f32_16x16x32_bf16 v[52:55], v[112:115], a[52:55], v[52:55]
    v_mfma_f32_16x16x32_bf16 v[56:59], v[116:119], a[52:55], v[56:59]
    ds_read_b128 v[140:143], v15 offset:17408
    v_mfma_f32_16x16x32_bf16 v[60:63], v[120:123], a[52:55], v[60:63]
    global_load_dwordx4 a[176:179], v1, s[52:53] offset:0 sc1
    v_mfma_f32_16x16x32_bf16 v[64:67], v[124:127], a[52:55], v[64:67]
    ds_read_b128 v[144:147], v15 offset:18432
    v_mfma_f32_16x16x32_bf16 v[68:71], v[128:131], a[52:55], v[68:71]
    v_mfma_f32_16x16x32_bf16 v[72:75], v[112:115], a[56:59], v[72:75]
    ds_read_b128 v[148:151], v15 offset:19456
    v_mfma_f32_16x16x32_bf16 v[76:79], v[116:119], a[56:59], v[76:79]
    s_waitcnt vmcnt(13)
    s_barrier
    buffer_store_dword v14, v0, s[40:43], s59 offen sc1
    v_mfma_f32_16x16x32_bf16 v[80:83], v[120:123], a[56:59], v[80:83]
    v_mfma_f32_16x16x32_bf16 v[84:87], v[124:127], a[56:59], v[84:87]
    global_load_dwordx4 a[180:183], v1, s[52:53] offset:1024 sc1
    v_mfma_f32_16x16x32_bf16 v[88:91], v[128:131], a[56:59], v[88:91]
    v_mfma_f32_16x16x32_bf16 v[92:95], v[112:115], a[60:63], v[92:95]
    v_mfma_f32_16x16x32_bf16 v[96:99], v[116:119], a[60:63], v[96:99]
    v_mfma_f32_16x16x32_bf16 v[100:103], v[120:123], a[60:63], v[100:103]
    v_mfma_f32_16x16x32_bf16 v[104:107], v[124:127], a[60:63], v[104:107]
    v_mfma_f32_16x16x32_bf16 v[108:111], v[128:131], a[60:63], v[108:111]
    s_waitcnt lgkmcnt(4)
    v_mfma_f32_16x16x32_bf16 v[32:35], v[132:135], a[64:67], v[32:35]
    global_load_dwordx4 a[184:187], v1, s[52:53] offset:2048 sc1
    s_waitcnt lgkmcnt(3)
    v_mfma_f32_16x16x32_bf16 v[36:39], v[136:139], a[64:67], v[36:39]
    s_waitcnt lgkmcnt(2)
    v_mfma_f32_16x16x32_bf16 v[40:43], v[140:143], a[64:67], v[40:43]
    ds_read_b128 v[112:115], v15 offset:20480
    s_waitcnt lgkmcnt(2)
    v_mfma_f32_16x16x32_bf16 v[44:47], v[144:147], a[64:67], v[44:47]
    s_waitcnt lgkmcnt(1)
    v_mfma_f32_16x16x32_bf16 v[48:51], v[148:151], a[64:67], v[48:51]
    ds_read_b128 v[116:119], v15 offset:21504
    v_mfma_f32_16x16x32_bf16 v[52:55], v[132:135], a[68:71], v[52:55]
    v_mfma_f32_16x16x32_bf16 v[56:59], v[136:139], a[68:71], v[56:59]
    ds_read_b128 v[120:123], v15 offset:22528
    global_load_dwordx4 a[188:191], v1, s[52:53] offset:3072 sc1
    v_mfma_f32_16x16x32_bf16 v[60:63], v[140:143], a[68:71], v[60:63]
    v_mfma_f32_16x16x32_bf16 v[64:67], v[144:147], a[68:71], v[64:67]
    ds_read_b128 v[124:127], v15 offset:23552
    v_mfma_f32_16x16x32_bf16 v[68:71], v[148:151], a[68:71], v[68:71]
    v_mfma_f32_16x16x32_bf16 v[72:75], v[132:135], a[72:75], v[72:75]
    ds_read_b128 v[128:131], v15 offset:24576
    v_mfma_f32_16x16x32_bf16 v[76:79], v[136:139], a[72:75], v[76:79]
    v_mfma_f32_16x16x32_bf16 v[80:83], v[140:143], a[72:75], v[80:83]
    v_mfma_f32_16x16x32_bf16 v[84:87], v[144:147], a[72:75], v[84:87]
    s_add_u32 s52, s52, 8192
    s_addc_u32 s53, s53, 0
    global_load_dwordx4 a[224:227], v1, s[52:53] offset:-4096 sc1
    v_mfma_f32_16x16x32_bf16 v[88:91], v[148:151], a[72:75], v[88:91]
    v_mfma_f32_16x16x32_bf16 v[92:95], v[132:135], a[76:79], v[92:95]
    v_mfma_f32_16x16x32_bf16 v[96:99], v[136:139], a[76:79], v[96:99]
    v_mfma_f32_16x16x32_bf16 v[100:103], v[140:143], a[76:79], v[100:103]
    v_mfma_f32_16x16x32_bf16 v[104:107], v[144:147], a[76:79], v[104:107]
    v_mfma_f32_16x16x32_bf16 v[108:111], v[148:151], a[76:79], v[108:111]
    s_waitcnt lgkmcnt(4)
    v_mfma_f32_16x16x32_bf16 v[32:35], v[112:115], a[80:83], v[32:35]
    global_load_dwordx4 a[228:231], v1, s[52:53] offset:-3072 sc1
    s_waitcnt lgkmcnt(3)
    v_mfma_f32_16x16x32_bf16 v[36:39], v[116:119], a[80:83], v[36:39]
    s_waitcnt lgkmcnt(2)
    v_mfma_f32_16x16x32_bf16 v[40:43], v[120:123], a[80:83], v[40:43]
    ds_read_b128 v[132:135], v15 offset:25600
    s_waitcnt lgkmcnt(2)
    v_mfma_f32_16x16x32_bf16 v[44:47], v[124:127], a[80:83], v[44:47]
    s_waitcnt lgkmcnt(1)
    v_mfma_f32_16x16x32_bf16 v[48:51], v[128:131], a[80:83], v[48:51]
    ds_read_b128 v[136:139], v15 offset:26624
    v_mfma_f32_16x16x32_bf16 v[52:55], v[112:115], a[84:87], v[52:55]
    v_mfma_f32_16x16x32_bf16 v[56:59], v[116:119], a[84:87], v[56:59]
    ds_read_b128 v[140:143], v15 offset:27648
    global_load_dwordx4 a[232:235], v1, s[52:53] offset:-2048 sc1
    v_mfma_f32_16x16x32_bf16 v[60:63], v[120:123], a[84:87], v[60:63]
    v_mfma_f32_16x16x32_bf16 v[64:67], v[124:127], a[84:87], v[64:67]
    ds_read_b128 v[144:147], v15 offset:28672
    v_mfma_f32_16x16x32_bf16 v[68:71], v[128:131], a[84:87], v[68:71]
    v_mfma_f32_16x16x32_bf16 v[72:75], v[112:115], a[88:91], v[72:75]
    ds_read_b128 v[148:151], v15 offset:29696
    v_mfma_f32_16x16x32_bf16 v[76:79], v[116:119], a[88:91], v[76:79]
    v_mfma_f32_16x16x32_bf16 v[80:83], v[120:123], a[88:91], v[80:83]
    v_mfma_f32_16x16x32_bf16 v[84:87], v[124:127], a[88:91], v[84:87]
    global_load_dwordx4 a[236:239], v1, s[52:53] offset:-1024 sc1
    v_mfma_f32_16x16x32_bf16 v[88:91], v[128:131], a[88:91], v[88:91]
    v_mfma_f32_16x16x32_bf16 v[92:95], v[112:115], a[92:95], v[92:95]
    v_mfma_f32_16x16x32_bf16 v[96:99], v[116:119], a[92:95], v[96:99]
    v_mfma_f32_16x16x32_bf16 v[100:103], v[120:123], a[92:95], v[100:103]
    v_mfma_f32_16x16x32_bf16 v[104:107], v[124:127], a[92:95], v[104:107]
    v_mfma_f32_16x16x32_bf16 v[108:111], v[128:131], a[92:95], v[108:111]
    global_load_dwordx4 a[240:243], v1, s[52:53] offset:0 sc1
    s_waitcnt lgkmcnt(4)
    v_mfma_f32_16x16x32_bf16 v[32:35], v[132:135], a[96:99], v[32:35]
    s_waitcnt lgkmcnt(3)
    v_mfma_f32_16x16x32_bf16 v[36:39], v[136:139], a[96:99], v[36:39]
    s_waitcnt lgkmcnt(2)
    v_mfma_f32_16x16x32_bf16 v[40:43], v[140:143], a[96:99], v[40:43]
    s_waitcnt lgkmcnt(1)
    v_mfma_f32_16x16x32_bf16 v[44:47], v[144:147], a[96:99], v[44:47]
    s_waitcnt lgkmcnt(0)
    v_mfma_f32_16x16x32_bf16 v[48:51], v[148:151], a[96:99], v[48:51]
    v_mfma_f32_16x16x32_bf16 v[52:55], v[132:135], a[100:103], v[52:55]
    v_mfma_f32_16x16x32_bf16 v[56:59], v[136:139], a[100:103], v[56:59]
    global_load_dwordx4 a[244:247], v1, s[52:53] offset:1024 sc1
    v_mfma_f32_16x16x32_bf16 v[60:63], v[140:143], a[100:103], v[60:63]
    v_mfma_f32_16x16x32_bf16 v[64:67], v[144:147], a[100:103], v[64:67]
    v_mfma_f32_16x16x32_bf16 v[68:71], v[148:151], a[100:103], v[68:71]
    v_mfma_f32_16x16x32_bf16 v[72:75], v[132:135], a[104:107], v[72:75]
    v_mfma_f32_16x16x32_bf16 v[76:79], v[136:139], a[104:107], v[76:79]
    v_mfma_f32_16x16x32_bf16 v[80:83], v[140:143], a[104:107], v[80:83]
    global_load_dwordx4 a[248:251], v1, s[52:53] offset:2048 sc1
    v_mfma_f32_16x16x32_bf16 v[84:87], v[144:147], a[104:107], v[84:87]
    v_mfma_f32_16x16x32_bf16 v[88:91], v[148:151], a[104:107], v[88:91]
    v_mfma_f32_16x16x32_bf16 v[92:95], v[132:135], a[108:111], v[92:95]
    v_mfma_f32_16x16x32_bf16 v[96:99], v[136:139], a[108:111], v[96:99]
    v_mfma_f32_16x16x32_bf16 v[100:103], v[140:143], a[108:111], v[100:103]
    v_mfma_f32_16x16x32_bf16 v[104:107], v[144:147], a[108:111], v[104:107]
    v_mfma_f32_16x16x32_bf16 v[108:111], v[148:151], a[108:111], v[108:111]
    global_load_dwordx4 a[252:255], v1, s[52:53] offset:3072 sc1
    v_mfma_f32_16x16x32_bf16 v[32:35], v[152:155], a[112:115], v[32:35]
    v_mfma_f32_16x16x32_bf16 v[36:39], v[156:159], a[112:115], v[36:39]
    v_mfma_f32_16x16x32_bf16 v[40:43], v[160:163], a[112:115], v[40:43]
    v_mfma_f32_16x16x32_bf16 v[44:47], v[164:167], a[112:115], v[44:47]
    v_mfma_f32_16x16x32_bf16 v[48:51], v[168:171], a[112:115], v[48:51]
    v_mfma_f32_16x16x32_bf16 v[52:55], v[152:155], a[116:119], v[52:55]
    s_add_u32 s52, s52, 8192
    s_addc_u32 s53, s53, 0
    global_load_dwordx4 v[112:115], v1, s[52:53] offset:-4096 sc1
    v_mfma_f32_16x16x32_bf16 v[56:59], v[156:159], a[116:119], v[56:59]
    v_mfma_f32_16x16x32_bf16 v[60:63], v[160:163], a[116:119], v[60:63]
    v_mfma_f32_16x16x32_bf16 v[64:67], v[164:167], a[116:119], v[64:67]
    v_mfma_f32_16x16x32_bf16 v[68:71], v[168:171], a[116:119], v[68:71]
    buffer_load_dword v26, v27, s[40:43], s77 offen sc1
    v_mfma_f32_16x16x32_bf16 v[72:75], v[152:155], a[120:123], v[72:75]
    v_mfma_f32_16x16x32_bf16 v[76:79], v[156:159], a[120:123], v[76:79]
    v_mfma_f32_16x16x32_bf16 v[80:83], v[160:163], a[120:123], v[80:83]
    global_load_dwordx4 v[116:119], v1, s[52:53] offset:-3072 sc1
    v_mfma_f32_16x16x32_bf16 v[84:87], v[164:167], a[120:123], v[84:87]
    v_mfma_f32_16x16x32_bf16 v[88:91], v[168:171], a[120:123], v[88:91]
    v_mfma_f32_16x16x32_bf16 v[92:95], v[152:155], a[124:127], v[92:95]
    v_mfma_f32_16x16x32_bf16 v[96:99], v[156:159], a[124:127], v[96:99]
    v_mfma_f32_16x16x32_bf16 v[100:103], v[160:163], a[124:127], v[100:103]
    v_mfma_f32_16x16x32_bf16 v[104:107], v[164:167], a[124:127], v[104:107]
    v_mfma_f32_16x16x32_bf16 v[108:111], v[168:171], a[124:127], v[108:111]
    global_load_dwordx4 v[120:123], v1, s[52:53] offset:-2048 sc1
    v_mfma_f32_16x16x32_bf16 v[32:35], v[172:175], a[128:131], v[32:35]
    v_mfma_f32_16x16x32_bf16 v[36:39], v[176:179], a[128:131], v[36:39]
    v_mfma_f32_16x16x32_bf16 v[40:43], v[180:183], a[128:131], v[40:43]
    v_mfma_f32_16x16x32_bf16 v[44:47], v[184:187], a[128:131], v[44:47]
    v_mfma_f32_16x16x32_bf16 v[48:51], v[188:191], a[128:131], v[48:51]
    v_mfma_f32_16x16x32_bf16 v[52:55], v[172:175], a[132:135], v[52:55]
    global_load_dwordx4 v[124:127], v1, s[52:53] offset:-1024 sc1
    v_mfma_f32_16x16x32_bf16 v[56:59], v[176:179], a[132:135], v[56:59]
    v_mfma_f32_16x16x32_bf16 v[60:63], v[180:183], a[132:135], v[60:63]
    v_mfma_f32_16x16x32_bf16 v[64:67], v[184:187], a[132:135], v[64:67]
    v_mfma_f32_16x16x32_bf16 v[68:71], v[188:191], a[132:135], v[68:71]
    v_mfma_f32_16x16x32_bf16 v[72:75], v[172:175], a[136:139], v[72:75]
    v_mfma_f32_16x16x32_bf16 v[76:79], v[176:179], a[136:139], v[76:79]
    v_mfma_f32_16x16x32_bf16 v[80:83], v[180:183], a[136:139], v[80:83]
    global_load_dwordx4 v[128:131], v1, s[52:53] offset:0 sc1
    v_mfma_f32_16x16x32_bf16 v[84:87], v[184:187], a[136:139], v[84:87]
    v_mfma_f32_16x16x32_bf16 v[88:91], v[188:191], a[136:139], v[88:91]
    v_mfma_f32_16x16x32_bf16 v[92:95], v[172:175], a[140:143], v[92:95]
    v_mfma_f32_16x16x32_bf16 v[96:99], v[176:179], a[140:143], v[96:99]
    v_mfma_f32_16x16x32_bf16 v[100:103], v[180:183], a[140:143], v[100:103]
    v_mfma_f32_16x16x32_bf16 v[104:107], v[184:187], a[140:143], v[104:107]
    global_load_dwordx4 v[132:135], v1, s[52:53] offset:1024 sc1
    v_mfma_f32_16x16x32_bf16 v[108:111], v[188:191], a[140:143], v[108:111]
    v_mfma_f32_16x16x32_bf16 v[32:35], v[192:195], a[144:147], v[32:35]
    v_add_u32_e64 v29, s74, v1
    v_mfma_f32_16x16x32_bf16 v[36:39], v[196:199], a[144:147], v[36:39]
    s_xor_b32 s58, s44, 1
    v_mfma_f32_16x16x32_bf16 v[40:43], v[200:203], a[144:147], v[40:43]
    s_mul_i32 s58, s58, 30720
    v_mfma_f32_16x16x32_bf16 v[44:47], v[204:207], a[144:147], v[44:47]
    v_add_u32 v6, s58, v1
    v_mfma_f32_16x16x32_bf16 v[48:51], v[208:211], a[144:147], v[48:51]
    s_xor_b32 s58, s44, 2
    v_mfma_f32_16x16x32_bf16 v[52:55], v[192:195], a[148:151], v[52:55]
    global_load_dwordx4 v[136:139], v1, s[52:53] offset:2048 sc1
    s_mul_i32 s58, s58, 30720
    v_mfma_f32_16x16x32_bf16 v[56:59], v[196:199], a[148:151], v[56:59]
    v_add_u32 v7, s58, v1
    v_mfma_f32_16x16x32_bf16 v[60:63], v[200:203], a[148:151], v[60:63]
    s_xor_b32 s58, s44, 3
    v_mfma_f32_16x16x32_bf16 v[64:67], v[204:207], a[148:151], v[64:67]
    s_mul_i32 s58, s58, 30720
    v_mfma_f32_16x16x32_bf16 v[68:71], v[208:211], a[148:151], v[68:71]
    v_add_u32 v8, s58, v1
    v_mfma_f32_16x16x32_bf16 v[72:75], v[192:195], a[152:155], v[72:75]
    s_lshl_b32 s58, s45, 2
    v_mfma_f32_16x16x32_bf16 v[76:79], v[196:199], a[152:155], v[76:79]
    global_load_dwordx4 v[140:143], v1, s[52:53] offset:3072 sc1
    s_add_u32 s58, s58, s44
    v_mfma_f32_16x16x32_bf16 v[80:83], v[200:203], a[152:155], v[80:83]
    s_mul_i32 s58, s58, 20480
    v_mfma_f32_16x16x32_bf16 v[84:87], v[204:207], a[152:155], v[84:87]
    s_mul_i32 s57, s46, 160
    v_mfma_f32_16x16x32_bf16 v[88:91], v[208:211], a[152:155], v[88:91]
    s_add_u32 s58, s58, s57
    v_mfma_f32_16x16x32_bf16 v[92:95], v[192:195], a[156:159], v[92:95]
    v_lshrrev_b32 v5, 4, v28
    v_mfma_f32_16x16x32_bf16 v[96:99], v[196:199], a[156:159], v[96:99]
    v_lshl_add_u32 v5, v5, 3, v18
    v_mfma_f32_16x16x32_bf16 v[100:103], v[200:203], a[156:159], v[100:103]
    v_mfma_f32_16x16x32_bf16 v[104:107], v[204:207], a[156:159], v[104:107]
    s_add_u32 s52, s52, 8192
    s_addc_u32 s53, s53, 0
    global_load_dwordx4 v[144:147], v1, s[52:53] offset:-4096 sc1
    v_mfma_f32_16x16x32_bf16 v[108:111], v[208:211], a[156:159], v[108:111]
    s_waitcnt vmcnt(34)
    v_mfma_f32_16x16x32_bf16 v[32:35], v[212:215], a[192:195], v[32:35]
    v_mfma_f32_16x16x32_bf16 v[36:39], v[216:219], a[192:195], v[36:39]
    v_mfma_f32_16x16x32_bf16 v[40:43], v[220:223], a[192:195], v[40:43]
    v_mfma_f32_16x16x32_bf16 v[44:47], v[224:227], a[192:195], v[44:47]
    v_mfma_f32_16x16x32_bf16 v[48:51], v[228:231], a[192:195], v[48:51]
    s_waitcnt vmcnt(33)
    v_mfma_f32_16x16x32_bf16 v[52:55], v[212:215], a[196:199], v[52:55]
    v_mfma_f32_16x16x32_bf16 v[56:59], v[216:219], a[196:199], v[56:59]
    v_mfma_f32_16x16x32_bf16 v[60:63], v[220:223], a[196:199], v[60:63]
    s_waitcnt vmcnt(8)
    v_cmp_gt_u32 vcc, 1, v26
    s_nop 0
    s_cbranch_vccz L_f3_ok
    s_mov_b32 s78, 0x40000
L_f3_spin:
    buffer_load_dword v26, v27, s[40:43], s77 offen sc1
    s_waitcnt vmcnt(0)
    v_cmp_gt_u32 vcc, 1, v26
    s_nop 1
    s_cbranch_vccz L_f3_ok
    s_sub_u32 s78, s78, 1
    s_cmp_lg_u32 s78, 0
    s_cbranch_scc1 L_f3_spin
L_f3_ok:
    v_mfma_f32_16x16x32_bf16 v[64:67], v[224:227], a[196:199], v[64:67]
    buffer_load_dwordx4 a[12:15], v25, s[40:43], s60 offen sc1
    v_mfma_f32_16x16x32_bf16 v[68:71], v[228:231], a[196:199], v[68:71]
    buffer_load_dwordx4 a[28:31], v25, s[40:43], s61 offen sc1
    v_mfma_f32_16x16x32_bf16 v[72:75], v[212:215], a[200:203], v[72:75]
    v_mfma_f32_16x16x32_bf16 v[76:79], v[216:219], a[200:203], v[76:79]
    v_mfma_f32_16x16x32_bf16 v[80:83], v[220:223], a[200:203], v[80:83]
    v_mfma_f32_16x16x32_bf16 v[84:87], v[224:227], a[200:203], v[84:87]
    buffer_load_dwordx4 a[44:47], v25, s[40:43], s62 offen sc1
    v_mfma_f32_16x16x32_bf16 v[88:91], v[228:231], a[200:203], v[88:91]
    v_mfma_f32_16x16x32_bf16 v[92:95], v[212:215], a[204:207], v[92:95]
    v_mfma_f32_16x16x32_bf16 v[96:99], v[216:219], a[204:207], v[96:99]
    v_mfma_f32_16x16x32_bf16 v[100:103], v[220:223], a[204:207], v[100:103]
    buffer_load_dwordx4 a[60:63], v25, s[40:43], s63 offen sc1
    v_mfma_f32_16x16x32_bf16 v[104:107], v[224:227], a[204:207], v[104:107]
    v_mfma_f32_16x16x32_bf16 v[108:111], v[228:231], a[204:207], v[108:111]
    v_mfma_f32_16x16x32_bf16 v[32:35], v[232:235], a[208:211], v[32:35]
    v_mfma_f32_16x16x32_bf16 v[36:39], v[236:239], a[208:211], v[36:39]
    buffer_load_dwordx4 a[76:79], v25, s[40:43], s68 offen sc1
    v_mfma_f32_16x16x32_bf16 v[40:43], v[240:243], a[208:211], v[40:43]
    v_mfma_f32_16x16x32_bf16 v[44:47], v[244:247], a[208:211], v[44:47]
    v_mfma_f32_16x16x32_bf16 v[48:51], v[248:251], a[208:211], v[48:51]
    v_mfma_f32_16x16x32_bf16 v[52:55], v[232:235], a[212:215], v[52:55]
    buffer_load_dwordx4 a[8:11], v24, s[40:43], s60 offen sc1
    v_mfma_f32_16x16x32_bf16 v[56:59], v[236:239], a[212:215], v[56:59]
    v_mfma_f32_16x16x32_bf16 v[60:63], v[240:243], a[212:215], v[60:63]
    v_mfma_f32_16x16x32_bf16 v[64:67], v[244:247], a[212:215], v[64:67]
    v_mfma_f32_16x16x32_bf16 v[68:71], v[248:251], a[212:215], v[68:71]
    buffer_load_dwordx4 a[24:27], v24, s[40:43], s61 offen sc1
    v_mfma_f32_16x16x32_bf16 v[72:75], v[232:235], a[216:219], v[72:75]
    v_mfma_f32_16x16x32_bf16 v[76:79], v[236:239], a[216:219], v[76:79]
    v_mfma_f32_16x16x32_bf16 v[80:83], v[240:243], a[216:219], v[80:83]
    v_mfma_f32_16x16x32_bf16 v[84:87], v[244:247], a[216:219], v[84:87]
    buffer_load_dwordx4 a[40:43], v24, s[40:43], s62 offen sc1
    v_mfma_f32_16x16x32_bf16 v[88:91], v[248:251], a[216:219], v[88:91]
    v_mfma_f32_16x16x32_bf16 v[92:95], v[232:235], a[220:223], v[92:95]
    v_mfma_f32_16x16x32_bf16 v[96:99], v[236:239], a[220:223], v[96:99]
    v_mfma_f32_16x16x32_bf16 v[100:103], v[240:243], a[220:223], v[100:103]
    buffer_load_dwordx4 a[56:59], v24, s[40:43], s63 offen sc1
    v_mfma_f32_16x16x32_bf16 v[104:107], v[244:247], a[220:223], v[104:107]
    v_mfma_f32_16x16x32_bf16 v[108:111], v[248:251], a[220:223], v[108:111]
    s_waitcnt vmcnt(8)
    v_mfma_f32_16x16x32_bf16 v[92:95], a[160:163], a[12:15], v[92:95]
    v_mfma_f32_16x16x32_bf16 v[96:99], a[164:167], a[12:15], v[96:99]
    buffer_load_dwordx4 a[72:75], v24, s[40:43], s68 offen sc1
    v_mfma_f32_16x16x32_bf16 v[100:103], a[168:171], a[12:15], v[100:103]
    v_mfma_f32_16x16x32_bf16 v[104:107], a[172:175], a[12:15], v[104:107]
    v_mfma_f32_16x16x32_bf16 v[108:111], a[176:179], a[12:15], v[108:111]
    s_waitcnt vmcnt(8)
    v_mfma_f32_16x16x32_bf16 v[92:95], a[180:183], a[28:31], v[92:95]
    buffer_load_dwordx4 a[4:7], v23, s[40:43], s60 offen sc1
    v_mfma_f32_16x16x32_bf16 v[96:99], a[184:187], a[28:31], v[96:99]
    v_mfma_f32_16x16x32_bf16 v[100:103], a[188:191], a[28:31], v[100:103]
    v_mfma_f32_16x16x32_bf16 v[104:107], a[224:227], a[28:31], v[104:107]
    v_mfma_f32_16x16x32_bf16 v[108:111], a[228:231], a[28:31], v[108:111]
    buffer_load_dwordx4 a[20:23], v23, s[40:43], s61 offen sc1
    s_waitcnt vmcnt(9)
    v_mfma_f32_16x16x32_bf16 v[92:95], a[232:235], a[44:47], v[92:95]
    v_mfma_f32_16x16x32_bf16 v[96:99], a[236:239], a[44:47], v[96:99]
    v_mfma_f32_16x16x32_bf16 v[100:103], a[240:243], a[44:47], v[100:103]
    v_mfma_f32_16x16x32_bf16 v[104:107], a[244:247], a[44:47], v[104:107]
    buffer_load_dwordx4 a[36:39], v23, s[40:43], s62 offen sc1
    v_mfma_f32_16x16x32_bf16 v[108:111], a[248:251], a[44:47], v[108:111]
    s_waitcnt vmcnt(9)
    v_mfma_f32_16x16x32_bf16 v[92:95], a[252:255], a[60:63], v[92:95]
    v_mfma_f32_16x16x32_bf16 v[96:99], v[112:115], a[60:63], v[96:99]
    v_mfma_f32_16x16x32_bf16 v[100:103], v[116:119], a[60:63], v[100:103]
    buffer_load_dwordx4 a[52:55], v23, s[40:43], s63 offen sc1
    v_mfma_f32_16x16x32_bf16 v[104:107], v[120:123], a[60:63], v[104:107]
    v_mfma_f32_16x16x32_bf16 v[108:111], v[124:127], a[60:63], v[108:111]
    s_waitcnt vmcnt(9)
    v_mfma_f32_16x16x32_bf16 v[92:95], v[128:131], a[76:79], v[92:95]
    v_mfma_f32_16x16x32_bf16 v[96:99], v[132:135], a[76:79], v[96:99]
    buffer_load_dwordx4 a[68:71], v23, s[40:43], s68 offen sc1
    v_mfma_f32_16x16x32_bf16 v[100:103], v[136:139], a[76:79], v[100:103]
    v_mfma_f32_16x16x32_bf16 v[104:107], v[140:143], a[76:79], v[104:107]
    v_mfma_f32_16x16x32_bf16 v[108:111], v[144:147], a[76:79], v[108:111]
    s_waitcnt vmcnt(9)
    v_mfma_f32_16x16x32_bf16 v[72:75], a[160:163], a[8:11], v[72:75]
    buffer_load_dwordx4 a[0:3], v22, s[40:43], s60 offen sc1
    v_mfma_f32_16x16x32_bf16 v[76:79], a[164:167], a[8:11], v[76:79]
    v_mfma_f32_16x16x32_bf16 v[80:83], a[168:171], a[8:11], v[80:83]
    v_mfma_f32_16x16x32_bf16 v[84:87], a[172:175], a[8:11], v[84:87]
    ds_write_b128 v29, v[92:95] offset:10240
    v_mfma_f32_16x16x32_bf16 v[88:91], a[176:179], a[8:11], v[88:91]
    buffer_load_dwordx4 a[16:19], v22, s[40:43], s61 offen sc1
    s_waitcnt vmcnt(10)
    v_mfma_f32_16x16x32_bf16 v[72:75], a[180:183], a[24:27], v[72:75]
    v_mfma_f32_16x16x32_bf16 v[76:79], a[184:187], a[24:27], v[76:79]
    v_mfma_f32_16x16x32_bf16 v[80:83], a[188:191], a[24:27], v[80:83]
    ds_write_b128 v29, v[96:99] offset:11264
    v_mfma_f32_16x16x32_bf16 v[84:87], a[224:227], a[24:27], v[84:87]
    buffer_load_dwordx4 a[32:35], v22, s[40:43], s62 offen sc1
    v_mfma_f32_16x16x32_bf16 v[88:91], a[228:231], a[24:27], v[88:91]
    s_waitcnt vmcnt(10)
    v_mfma_f32_16x16x32_bf16 v[72:75], a[232:235], a[40:43], v[72:75]
    v_mfma_f32_16x16x32_bf16 v[76:79], a[236:239], a[40:43], v[76:79]
    ds_write_b128 v29, v[100:103] offset:12288
    v_mfma_f32_16x16x32_bf16 v[80:83], a[240:243], a[40:43], v[80:83]
    buffer_load_dwordx4 a[48:51], v22, s[40:43], s63 offen sc1
    v_mfma_f32_16x16x32_bf16 v[84:87], a[244:247], a[40:43], v[84:87]
    v_mfma_f32_16x16x32_bf16 v[88:91], a[248:251], a[40:43], v[88:91]
    s_waitcnt vmcnt(10)
    v_mfma_f32_16x16x32_bf16 v[72:75], a[252:255], a[56:59], v[72:75]
    ds_write_b128 v29, v[104:107] offset:13312
    v_mfma_f32_16x16x32_bf16 v[76:79], v[112:115], a[56:59], v[76:79]
    buffer_load_dwordx4 a[64:67], v22, s[40:43], s68 offen sc1
    v_mfma_f32_16x16x32_bf16 v[80:83], v[116:119], a[56:59], v[80:83]
    v_mfma_f32_16x16x32_bf16 v[84:87], v[120:123], a[56:59], v[84:87]
    v_mfma_f32_16x16x32_bf16 v[88:91], v[124:127], a[56:59], v[88:91]
    ds_write_b128 v29, v[108:111] offset:14336
    s_waitcnt vmcnt(10)
    v_mfma_f32_16x16x32_bf16 v[72:75], v[128:131], a[72:75], v[72:75]
    v_mfma_f32_16x16x32_bf16 v[76:79], v[132:135], a[72:75], v[76:79]
    v_mfma_f32_16x16x32_bf16 v[80:83], v[136:139], a[72:75], v[80:83]
    v_mfma_f32_16x16x32_bf16 v[84:87], v[140:143], a[72:75], v[84:87]
    v_mfma_f32_16x16x32_bf16 v[88:91], v[144:147], a[72:75], v[88:91]
    s_waitcnt vmcnt(9)
    v_mfma_f32_16x16x32_bf16 v[52:55], a[160:163], a[4:7], v[52:55]
    v_mfma_f32_16x16x32_bf16 v[56:59], a[164:167], a[4:7], v[56:59]
    v_mfma_f32_16x16x32_bf16 v[60:63], a[168:171], a[4:7], v[60:63]
    v_mfma_f32_16x16x32_bf16 v[64:67], a[172:175], a[4:7], v[64:67]
    ds_write_b128 v29, v[72:75] offset:5120
    v_mfma_f32_16x16x32_bf16 v[68:71], a[176:179], a[4:7], v[68:71]
    s_waitcnt vmcnt(8)
    v_mfma_f32_16x16x32_bf16 v[52:55], a[180:183], a[20:23], v[52:55]
    v_mfma_f32_16x16x32_bf16 v[56:59], a[184:187], a[20:23], v[56:59]
    v_mfma_f32_16x16x32_bf16 v[60:63], a[188:191], a[20:23], v[60:63]
    ds_write_b128 v29, v[76:79] offset:6144
    v_mfma_f32_16x16x32_bf16 v[64:67], a[224:227], a[20:23], v[64:67]
    v_mfma_f32_16x16x32_bf16 v[68:71], a[228:231], a[20:23], v[68:71]
    s_waitcnt vmcnt(7)
    v_mfma_f32_16x16x32_bf16 v[52:55], a[232:235], a[36:39], v[52:55]
    v_mfma_f32_16x16x32_bf16 v[56:59], a[236:239], a[36:39], v[56:59]
    ds_write_b128 v29, v[80:83] offset:7168
    v_mfma_f32_16x16x32_bf16 v[60:63], a[240:243], a[36:39], v[60:63]
    v_mfma_f32_16x16x32_bf16 v[64:67], a[244:247], a[36:39], v[64:67]
    v_mfma_f32_16x16x32_bf16 v[68:71], a[248:251], a[36:39], v[68:71]
    s_waitcnt vmcnt(6)
    v_mfma_f32_16x16x32_bf16 v[52:55], a[252:255], a[52:55], v[52:55]
    ds_write_b128 v29, v[84:87] offset:8192
    v_mfma_f32_16x16x32_bf16 v[56:59], v[112:115], a[52:55], v[56:59]
    v_mfma_f32_16x16x32_bf16 v[60:63], v[116:119], a[52:55], v[60:63]
    v_mfma_f32_16x16x32_bf16 v[64:67], v[120:123], a[52:55], v[64:67]
    v_mfma_f32_16x16x32_bf16 v[68:71], v[124:127], a[52:55], v[68:71]
    ds_write_b128 v29, v[88:91] offset:9216
    s_waitcnt vmcnt(5)
    v_mfma_f32_16x16x32_bf16 v[52:55], v[128:131], a[68:71], v[52:55]
    s_waitcnt lgkmcnt(0)
    s_barrier
    ds_read_b128 v[92:95], v8 offset:10240
    ds_read_b128 v[96:99], v8 offset:11264
    v_mfma_f32_16x16x32_bf16 v[56:59], v[132:135], a[68:71], v[56:59]
    ds_read_b128 v[100:103], v8 offset:12288
    ds_read_b128 v[104:107], v8 offset:13312
    v_mfma_f32_16x16x32_bf16 v[60:63], v[136:139], a[68:71], v[60:63]
    ds_read_b128 v[108:111], v8 offset:14336
    ds_read_b128 v[72:75], v7 offset:5120
    v_mfma_f32_16x16x32_bf16 v[64:67], v[140:143], a[68:71], v[64:67]
    ds_read_b128 v[76:79], v7 offset:6144
    ds_read_b128 v[80:83], v7 offset:7168
    v_mfma_f32_16x16x32_bf16 v[68:71], v[144:147], a[68:71], v[68:71]
    ds_read_b128 v[84:87], v7 offset:8192
    ds_read_b128 v[88:91], v7 offset:9216
    s_waitcnt vmcnt(4)
    v_mfma_f32_16x16x32_bf16 v[32:35], a[160:163], a[0:3], v[32:35]
    v_mfma_f32_16x16x32_bf16 v[36:39], a[164:167], a[0:3], v[36:39]
    v_mfma_f32_16x16x32_bf16 v[40:43], a[168:171], a[0:3], v[40:43]
    v_mfma_f32_16x16x32_bf16 v[44:47], a[172:175], a[0:3], v[44:47]
    ds_write_b128 v29, v[52:55] offset:0
    v_mfma_f32_16x16x32_bf16 v[48:51], a[176:179], a[0:3], v[48:51]
    s_waitcnt vmcnt(3)
    v_mfma_f32_16x16x32_bf16 v[32:35], a[180:183], a[16:19], v[32:35]
    ds_write_b128 v29, v[56:59] offset:1024
    v_mfma_f32_16x16x32_bf16 v[36:39], a[184:187], a[16:19], v[36:39]
    v_mfma_f32_16x16x32_bf16 v[40:43], a[188:191], a[16:19], v[40:43]
    ds_write_b128 v29, v[60:63] offset:2048
    v_mfma_f32_16x16x32_bf16 v[44:47], a[224:227], a[16:19], v[44:47]
    s_waitcnt lgkmcnt(7)
    v_add_f32 v92, v92, v72
    v_add_f32 v93, v93, v73
    v_add_f32 v94, v94, v74
    v_add_f32 v95, v95, v75
    v_mfma_f32_16x16x32_bf16 v[48:51], a[228:231], a[16:19], v[48:51]
    ds_write_b128 v29, v[64:67] offset:3072
    s_waitcnt lgkmcnt(7)
    v_add_f32 v96, v96, v76
    v_add_f32 v97, v97, v77
    v_add_f32 v98, v98, v78
    v_add_f32 v99, v99, v79
    s_waitcnt vmcnt(2)
    v_mfma_f32_16x16x32_bf16 v[32:35], a[232:235], a[32:35], v[32:35]
    s_waitcnt lgkmcnt(6)
    v_add_f32 v100, v100, v80
    v_add_f32 v101, v101, v81
    v_add_f32 v102, v102, v82
    v_add_f32_e64 v103, v103, v83
    v_mfma_f32_16x16x32_bf16 v[36:39], a[236:239], a[32:35], v[36:39]
    ds_write_b128 v29, v[68:71] offset:4096
    s_waitcnt lgkmcnt(6)
    v_add_f32 v104, v104, v84
    v_add_f32 v105, v105, v85
    v_add_f32 v106, v106, v86
    v_add_f32_e64 v107, v107, v87
    v_mfma_f32_16x16x32_bf16 v[40:43], a[240:243], a[32:35], v[40:43]
    s_waitcnt lgkmcnt(5)
    v_add_f32 v108, v108, v88
    v_add_f32 v109, v109, v89
    v_add_f32 v110, v110, v90
    v_add_f32_e64 v111, v111, v91
    v_mfma_f32_16x16x32_bf16 v[44:47], a[244:247], a[32:35], v[44:47]
    v_mfma_f32_16x16x32_bf16 v[48:51], a[248:251], a[32:35], v[48:51]
    s_waitcnt lgkmcnt(0)
    s_barrier
    ds_read_b128 v[52:55], v6 offset:0
    ds_read_b128 v[56:59], v6 offset:1024
    s_waitcnt vmcnt(1)
    v_mfma_f32_16x16x32_bf16 v[32:35], a[252:255], a[48:51], v[32:35]
    ds_read_b128 v[60:63], v6 offset:2048
    ds_read_b128 v[64:67], v6 offset:3072
    s_waitcnt vmcnt(0)
    v_mfma_f32_16x16x32_bf16 v[32:35], v[128:131], a[64:67], v[32:35]
    ds_read_b128 v[68:71], v6 offset:4096
    v_mfma_f32_16x16x32_bf16 v[36:39], v[112:115], a[48:51], v[36:39]
    v_mfma_f32_16x16x32_bf16 v[36:39], v[132:135], a[64:67], v[36:39]
    s_waitcnt lgkmcnt(4)
    v_add_f32 v92, v92, v52
    v_add_f32 v93, v93, v53
    v_add_f32 v94, v94, v54
    v_add_f32_e64 v95, v95, v55
    v_mfma_f32_16x16x32_bf16 v[40:43], v[116:119], a[48:51], v[40:43]
    s_waitcnt lgkmcnt(3)
    v_add_f32 v96, v96, v56
    v_add_f32 v97, v97, v57
    v_add_f32 v98, v98, v58
    v_add_f32_e64 v99, v99, v59
    v_mfma_f32_16x16x32_bf16 v[40:43], v[136:139], a[64:67], v[40:43]
    s_waitcnt lgkmcnt(2)
    v_add_f32 v100, v100, v60
    v_add_f32 v101, v101, v61
    v_add_f32 v102, v102, v62
    v_add_f32_e64 v103, v103, v63
    v_mfma_f32_16x16x32_bf16 v[44:47], v[120:123], a[48:51], v[44:47]
    v_add_f32 v32, v32, v92
    v_add_f32 v33, v33, v93
    v_add_f32 v34, v34, v94
    v_add_f32 v35, v35, v95
    v_cvt_pk_bf16_f32 v216, v32, v33
    v_cvt_pk_bf16_f32 v217, v34, v35
    v_mfma_f32_16x16x32_bf16 v[44:47], v[140:143], a[64:67], v[44:47]
    s_waitcnt lgkmcnt(1)
    v_add_f32 v104, v104, v64
    v_add_f32 v105, v105, v65
    v_add_f32 v106, v106, v66
    v_add_f32_e64 v107, v107, v67
    v_mfma_f32_16x16x32_bf16 v[48:51], v[124:127], a[48:51], v[48:51]
    v_add_f32 v36, v36, v96
    v_add_f32 v37, v37, v97
    v_add_f32 v38, v38, v98
    v_add_f32 v39, v39, v99
    v_cvt_pk_bf16_f32 v218, v36, v37
    v_cvt_pk_bf16_f32 v219, v38, v39
    v_mfma_f32_16x16x32_bf16 v[48:51], v[144:147], a[64:67], v[48:51]
    s_waitcnt lgkmcnt(0)
    v_add_f32 v108, v108, v68
    v_add_f32 v109, v109, v69
    v_add_f32 v110, v110, v70
    v_add_f32 v111, v111, v71
    v_permlane32_swap_b32 v216, v218
    v_permlane32_swap_b32 v217, v219
    s_nop 0
    v_permlane16_swap_b32 v216, v218
    v_permlane16_swap_b32 v217, v219
    buffer_store_dwordx4 v[216:219], v5, s[32:35], s58 offen offset:0
    v_pk_add_f32 v[40:41], v[40:41], v[100:101]
    v_pk_add_f32 v[42:43], v[42:43], v[102:103]
    v_cvt_pk_bf16_f32 v220, v40, v41
    v_cvt_pk_bf16_f32 v221, v42, v43
    v_pk_add_f32 v[44:45], v[44:45], v[104:105]
    v_pk_add_f32 v[46:47], v[46:47], v[106:107]
    v_cvt_pk_bf16_f32 v222, v44, v45
    v_cvt_pk_bf16_f32 v223, v46, v47
    v_pk_add_f32 v[48:49], v[48:49], v[108:109]
    v_pk_add_f32 v[50:51], v[50:51], v[110:111]
    v_cvt_pk_bf16_f32 v224, v48, v49
    v_cvt_pk_bf16_f32 v225, v50, v51
    buffer_store_dwordx2 v[224:225], v18, s[32:35], s58 offen offset:128
    v_permlane32_swap_b32 v220, v222
    v_permlane32_swap_b32 v221, v223
    s_nop 0
    v_permlane16_swap_b32 v220, v222
    v_permlane16_swap_b32 v221, v223
    buffer_store_dwordx4 v[220:223], v5, s[32:35], s58 offen offset:64
    s_endpgm
L_fallback:
    s_waitcnt vmcnt(0) lgkmcnt(0)
    s_mov_b32 s82, 1
    v_mov_b32 v100, 0xff800000
    v_mov_b32 v101, 0xff800000
    v_mov_b32 v102, 0xff800000
    v_mov_b32 v103, 0xff800000
    s_lshr_b32 s58, s44, 1
    s_lshl_b32 s58, s58, 17
    s_add_u32 s28, s40, s58
    s_addc_u32 s29, s41, 0
    s_mov_b32 s59, 32
L_fb_max:
    global_load_dwordx4 v[56:59], v1, s[28:29] sc1
    global_load_dwordx2 v[68:69], v4, s[28:29] offset:2560 sc1
    s_waitcnt vmcnt(0)
    v_mfma_f32_32x32x16_bf16 v[84:99], v[56:59], v[32:35], 0
    v_mfma_f32_32x32x8_bf16 v[84:99], v[68:69], v[36:37], v[84:99]
    s_nop 11
    v_max3_f32 v100, v100, v84, v85
    v_max3_f32 v100, v100, v86, v87
    v_max3_f32 v100, v100, v88, v89
    v_max3_f32 v100, v100, v90, v91
    v_max3_f32 v100, v100, v92, v93
    v_max3_f32 v100, v100, v94, v95
    v_max3_f32 v100, v100, v96, v97
    v_max3_f32 v100, v100, v98, v99
    s_nop 7
    v_mfma_f32_32x32x16_bf16 v[84:99], v[56:59], v[38:41], 0
    v_mfma_f32_32x32x8_bf16 v[84:99], v[68:69], v[42:43], v[84:99]
    s_nop 11
    v_max3_f32 v101, v101, v84, v85
    v_max3_f32 v101, v101, v86, v87
    v_max3_f32 v101, v101, v88, v89
    v_max3_f32 v101, v101, v90, v91
    v_max3_f32 v101, v101, v92, v93
    v_max3_f32 v101, v101, v94, v95
    v_max3_f32 v101, v101, v96, v97
    v_max3_f32 v101, v101, v98, v99
    s_nop 7
    v_mfma_f32_32x32x16_bf16 v[84:99], v[56:59], v[44:47], 0
    v_mfma_f32_32x32x8_bf16 v[84:99], v[68:69], v[48:49], v[84:99]
    s_nop 11
    v_max3_f32 v102, v102, v84, v85
    v_max3_f32 v102, v102, v86, v87
    v_max3_f32 v102, v102, v88, v89
    v_max3_f32 v102, v102, v90, v91
    v_max3_f32 v102, v102, v92, v93
    v_max3_f32 v102, v102, v94, v95
    v_max3_f32 v102, v102, v96, v97
    v_max3_f32 v102, v102, v98, v99
    s_nop 7
    v_mfma_f32_32x32x16_bf16 v[84:99], v[56:59], v[50:53], 0
    v_mfma_f32_32x32x8_bf16 v[84:99], v[68:69], v[54:55], v[84:99]
    s_nop 11
    v_max3_f32 v103, v103, v84, v85
    v_max3_f32 v103, v103, v86, v87
    v_max3_f32 v103, v103, v88, v89
    v_max3_f32 v103, v103, v90, v91
    v_max3_f32 v103, v103, v92, v93
    v_max3_f32 v103, v103, v94, v95
    v_max3_f32 v103, v103, v96, v97
    v_max3_f32 v103, v103, v98, v99
    s_nop 7
    s_add_u32 s28, s28, 4096
    s_addc_u32 s29, s29, 0
    s_sub_u32 s59, s59, 1
    s_cmp_lg_u32 s59, 0
    s_cbranch_scc1 L_fb_max
    v_mov_b32 v104, v100
    v_mov_b32 v105, v101
    v_mov_b32 v106, v102
    v_mov_b32 v107, v103
    v_permlane32_swap_b32 v100, v104
    v_permlane32_swap_b32 v101, v105
    v_permlane32_swap_b32 v102, v106
    v_permlane32_swap_b32 v103, v107
    v_max_f32 v100, v100, v104
    v_max_f32 v101, v101, v105
    v_max_f32 v102, v102, v106
    v_max_f32 v103, v103, v107
    s_barrier
    s_lshl_b32 s58, s44, 10
    s_add_u32 s58, s58, 147456
    v_add_u32_e64 v30, s58, v1
    s_xor_b32 s58, s44, 2
    s_lshl_b32 s58, s58, 10
    s_add_u32 s58, s58, 147456
    v_add_u32_e64 v31, s58, v1
    ds_write_b128 v30, v[100:103]
    s_waitcnt lgkmcnt(0)
    s_barrier
    ds_read_b128 v[104:107], v31
    s_waitcnt lgkmcnt(0)
    v_max_f32 v100, v100, v106
    v_max_f32 v101, v101, v107
    v_max_f32 v102, v102, v104
    v_max_f32 v103, v103, v105
    s_barrier
    v_accvgpr_write_b32 a192, 0
    v_accvgpr_write_b32 a193, 0
    v_accvgpr_write_b32 a194, 0
    v_accvgpr_write_b32 a195, 0
    v_accvgpr_write_b32 a196, 0
    v_accvgpr_write_b32 a197, 0
    v_accvgpr_write_b32 a198, 0
    v_accvgpr_write_b32 a199, 0
    v_accvgpr_write_b32 a200, 0
    v_accvgpr_write_b32 a201, 0
    v_accvgpr_write_b32 a202, 0
    v_accvgpr_write_b32 a203, 0
    v_accvgpr_write_b32 a204, 0
    v_accvgpr_write_b32 a205, 0
    v_accvgpr_write_b32 a206, 0
    v_accvgpr_write_b32 a207, 0
    v_accvgpr_write_b32 a208, 0
    v_accvgpr_write_b32 a209, 0
    v_accvgpr_write_b32 a210, 0
    v_accvgpr_write_b32 a211, 0
    v_accvgpr_write_b32 a212, 0
    v_accvgpr_write_b32 a213, 0
    v_accvgpr_write_b32 a214, 0
    v_accvgpr_write_b32 a215, 0
    v_accvgpr_write_b32 a216, 0
    v_accvgpr_write_b32 a217, 0
    v_accvgpr_write_b32 a218, 0
    v_accvgpr_write_b32 a219, 0
    v_accvgpr_write_b32 a220, 0
    v_accvgpr_write_b32 a221, 0
    v_accvgpr_write_b32 a222, 0
    v_accvgpr_write_b32 a223, 0
    v_accvgpr_write_b32 a224, 0
    v_accvgpr_write_b32 a225, 0
    v_accvgpr_write_b32 a226, 0
    v_accvgpr_write_b32 a227, 0
    v_accvgpr_write_b32 a228, 0
    v_accvgpr_write_b32 a229, 0
    v_accvgpr_write_b32 a230, 0
    v_accvgpr_write_b32 a231, 0
    v_accvgpr_write_b32 a232, 0
    v_accvgpr_write_b32 a233, 0
    v_accvgpr_write_b32 a234, 0
    v_accvgpr_write_b32 a235, 0
    v_accvgpr_write_b32 a236, 0
    v_accvgpr_write_b32 a237, 0
    v_accvgpr_write_b32 a238, 0
    v_accvgpr_write_b32 a239, 0
    v_accvgpr_write_b32 a240, 0
    v_accvgpr_write_b32 a241, 0
    v_accvgpr_write_b32 a242, 0
    v_accvgpr_write_b32 a243, 0
    v_accvgpr_write_b32 a244, 0
    v_accvgpr_write_b32 a245, 0
    v_accvgpr_write_b32 a246, 0
    v_accvgpr_write_b32 a247, 0
    v_accvgpr_write_b32 a248, 0
    v_accvgpr_write_b32 a249, 0
    v_accvgpr_write_b32 a250, 0
    v_accvgpr_write_b32 a251, 0
    v_accvgpr_write_b32 a252, 0
    v_accvgpr_write_b32 a253, 0
    v_accvgpr_write_b32 a254, 0
    v_accvgpr_write_b32 a255, 0
    s_lshr_b32 s58, s44, 1
    s_lshl_b32 s58, s58, 17
    s_add_u32 s28, s40, s58
    s_addc_u32 s29, s41, 0
    s_mov_b32 s59, 32
L_fb_pv:
    global_load_dwordx4 v[56:59], v1, s[28:29] sc1
    global_load_dwordx2 v[68:69], v4, s[28:29] offset:2560 sc1
    global_load_dwordx4 v[60:63], v3, s[28:29] offset:1024 sc1
    global_load_dwordx4 v[64:67], v3, s[28:29] offset:1792 sc1
    s_waitcnt vmcnt(0)
    v_mfma_f32_32x32x16_bf16 v[84:99], v[56:59], v[32:35], 0
    v_mfma_f32_32x32x8_bf16 v[84:99], v[68:69], v[36:37], v[84:99]
    s_nop 11
    v_sub_f32 v84, v84, v100
    v_sub_f32 v85, v85, v100
    v_sub_f32 v86, v86, v100
    v_sub_f32 v87, v87, v100
    v_sub_f32 v88, v88, v100
    v_sub_f32 v89, v89, v100
    v_sub_f32 v90, v90, v100
    v_sub_f32 v91, v91, v100
    v_sub_f32 v92, v92, v100
    v_sub_f32 v93, v93, v100
    v_sub_f32 v94, v94, v100
    v_sub_f32 v95, v95, v100
    v_sub_f32 v96, v96, v100
    v_sub_f32 v97, v97, v100
    v_sub_f32 v98, v98, v100
    v_sub_f32 v99, v99, v100
    v_exp_f32 v84, v84
    v_exp_f32 v85, v85
    v_exp_f32 v86, v86
    v_exp_f32 v87, v87
    v_exp_f32 v88, v88
    v_exp_f32 v89, v89
    v_exp_f32 v90, v90
    v_exp_f32 v91, v91
    v_exp_f32 v92, v92
    v_exp_f32 v93, v93
    v_exp_f32 v94, v94
    v_exp_f32 v95, v95
    v_exp_f32 v96, v96
    v_exp_f32 v97, v97
    v_exp_f32 v98, v98
    v_exp_f32_e64 v99, v99
    v_smfmac_f32_32x32x32_bf16 a[192:207], v[60:63], v[84:91], v2
    s_nop 0
    v_smfmac_f32_32x32x32_bf16 a[192:207], v[64:67], v[92:99], v2
    v_mfma_f32_32x32x16_bf16 v[84:99], v[56:59], v[38:41], 0
    v_mfma_f32_32x32x8_bf16 v[84:99], v[68:69], v[42:43], v[84:99]
    s_nop 11
    v_sub_f32 v84, v84, v101
    v_sub_f32 v85, v85, v101
    v_sub_f32 v86, v86, v101
    v_sub_f32 v87, v87, v101
    v_sub_f32 v88, v88, v101
    v_sub_f32 v89, v89, v101
    v_sub_f32 v90, v90, v101
    v_sub_f32 v91, v91, v101
    v_sub_f32 v92, v92, v101
    v_sub_f32 v93, v93, v101
    v_sub_f32 v94, v94, v101
    v_sub_f32 v95, v95, v101
    v_sub_f32 v96, v96, v101
    v_sub_f32 v97, v97, v101
    v_sub_f32 v98, v98, v101
    v_sub_f32 v99, v99, v101
    v_exp_f32 v84, v84
    v_exp_f32 v85, v85
    v_exp_f32 v86, v86
    v_exp_f32 v87, v87
    v_exp_f32 v88, v88
    v_exp_f32 v89, v89
    v_exp_f32 v90, v90
    v_exp_f32 v91, v91
    v_exp_f32 v92, v92
    v_exp_f32 v93, v93
    v_exp_f32 v94, v94
    v_exp_f32 v95, v95
    v_exp_f32 v96, v96
    v_exp_f32 v97, v97
    v_exp_f32 v98, v98
    v_exp_f32 v99, v99
    v_smfmac_f32_32x32x32_bf16 a[208:223], v[60:63], v[84:91], v2
    s_nop 0
    v_smfmac_f32_32x32x32_bf16 a[208:223], v[64:67], v[92:99], v2
    v_mfma_f32_32x32x16_bf16 v[84:99], v[56:59], v[44:47], 0
    v_mfma_f32_32x32x8_bf16 v[84:99], v[68:69], v[48:49], v[84:99]
    s_nop 11
    v_sub_f32 v84, v84, v102
    v_sub_f32 v85, v85, v102
    v_sub_f32 v86, v86, v102
    v_sub_f32 v87, v87, v102
    v_sub_f32 v88, v88, v102
    v_sub_f32 v89, v89, v102
    v_sub_f32 v90, v90, v102
    v_sub_f32 v91, v91, v102
    v_sub_f32 v92, v92, v102
    v_sub_f32 v93, v93, v102
    v_sub_f32 v94, v94, v102
    v_sub_f32 v95, v95, v102
    v_sub_f32 v96, v96, v102
    v_sub_f32 v97, v97, v102
    v_sub_f32 v98, v98, v102
    v_sub_f32 v99, v99, v102
    v_exp_f32 v84, v84
    v_exp_f32 v85, v85
    v_exp_f32 v86, v86
    v_exp_f32 v87, v87
    v_exp_f32 v88, v88
    v_exp_f32 v89, v89
    v_exp_f32 v90, v90
    v_exp_f32 v91, v91
    v_exp_f32 v92, v92
    v_exp_f32 v93, v93
    v_exp_f32 v94, v94
    v_exp_f32 v95, v95
    v_exp_f32 v96, v96
    v_exp_f32 v97, v97
    v_exp_f32 v98, v98
    v_exp_f32 v99, v99
    v_smfmac_f32_32x32x32_bf16 a[224:239], v[60:63], v[84:91], v2
    s_nop 0
    v_smfmac_f32_32x32x32_bf16 a[224:239], v[64:67], v[92:99], v2
    v_mfma_f32_32x32x16_bf16 v[84:99], v[56:59], v[50:53], 0
    v_mfma_f32_32x32x8_bf16 v[84:99], v[68:69], v[54:55], v[84:99]
    s_nop 11
    v_sub_f32 v84, v84, v103
    v_sub_f32 v85, v85, v103
    v_sub_f32 v86, v86, v103
    v_sub_f32 v87, v87, v103
    v_sub_f32 v88, v88, v103
    v_sub_f32 v89, v89, v103
    v_sub_f32 v90, v90, v103
    v_sub_f32 v91, v91, v103
    v_sub_f32 v92, v92, v103
    v_sub_f32 v93, v93, v103
    v_sub_f32 v94, v94, v103
    v_sub_f32 v95, v95, v103
    v_sub_f32 v96, v96, v103
    v_sub_f32 v97, v97, v103
    v_sub_f32 v98, v98, v103
    v_sub_f32 v99, v99, v103
    v_exp_f32 v84, v84
    v_exp_f32 v85, v85
    v_exp_f32 v86, v86
    v_exp_f32 v87, v87
    v_exp_f32 v88, v88
    v_exp_f32 v89, v89
    v_exp_f32 v90, v90
    v_exp_f32 v91, v91
    v_exp_f32 v92, v92
    v_exp_f32 v93, v93
    v_exp_f32 v94, v94
    v_exp_f32 v95, v95
    v_exp_f32 v96, v96
    v_exp_f32 v97, v97
    v_exp_f32 v98, v98
    v_exp_f32 v99, v99
    v_smfmac_f32_32x32x32_bf16 a[240:255], v[60:63], v[84:91], v2
    s_nop 0
    v_smfmac_f32_32x32x32_bf16 a[240:255], v[64:67], v[92:99], v2
    s_nop 15
    s_add_u32 s28, s28, 4096
    s_addc_u32 s29, s29, 0
    s_sub_u32 s59, s59, 1
    s_cmp_lg_u32 s59, 0
    s_cbranch_scc1 L_fb_pv
    s_nop 15
    ds_write_b128 v252, a[224:227] offset:0
    ds_write_b128 v252, a[228:231] offset:1024
    ds_write_b128 v252, a[232:235] offset:2048
    ds_write_b128 v252, a[240:243] offset:3072
    ds_write_b128 v252, a[244:247] offset:4096
    ds_write_b128 v252, a[248:251] offset:5120
    s_branch L_combine
L_end:
    s_endpgm

.section .rodata,"a"
.p2align 6
.amdhsa_kernel gated_mix__grouped_kv_mqa__dense_activation_relu__prompt_kernel
  .amdhsa_next_free_vgpr 512
  .amdhsa_next_free_sgpr 102
  .amdhsa_accum_offset 256
  .amdhsa_group_segment_fixed_size 0
  .amdhsa_kernarg_size 96
  .amdhsa_user_sgpr_count 2
  .amdhsa_user_sgpr_kernarg_segment_ptr 1
  .amdhsa_system_sgpr_workgroup_id_x 1
  .amdhsa_float_denorm_mode_32 3
.end_amdhsa_kernel
```
